```python
import torch

def _softmax(x, axis=-1):
    return torch.softmax(x, dim=axis)
def _gelu(x):
    return torch.nn.functional.gelu(x, approximate="tanh")
def _silu(x):
    return torch.nn.functional.silu(x)
def _sigmoid(x):
    return torch.sigmoid(x)
def _layernorm(x, axis=-1, eps=1e-5):
    m = x.mean(dim=axis, keepdim=True)
    v = x.var(dim=axis, keepdim=True, unbiased=False)
    return (x - m) / torch.sqrt(v + eps)
def _scatter_add(tgt, idx, src, axis=0):
    return tgt.clone().index_add_(axis, idx, src)
def _segment_sum(src, seg, n):
    out = torch.zeros((n,) + src.shape[1:], dtype=src.dtype)
    return out.index_add_(0, seg, src)
def _pad(x, pw):
    flat = tuple(v for pair in reversed(pw) for v in pair)
    return torch.nn.functional.pad(x, flat)

kernel_name = 'gated_mix__ssm_conv_s4__dense_activation_relu__prompt'

def setup_inputs():

    _w = (lambda a: (lambda t: t.to(torch.bfloat16) if t.is_floating_point() else t)(torch.as_tensor(a)))
    def _A_setup():
        B, L, D, N = 1, 2048, 640, 192
        A_re = -(lambda _x: torch.exp(torch.as_tensor(_x)))((lambda *s: torch.randn(*s, dtype=torch.bfloat16) * 6.4)(D, N))
        A_im = torch.pi * (lambda *s: torch.randn(*s, dtype=torch.bfloat16) * 0.1)(D, N)
        B_re = (lambda *s: torch.randn(*s, dtype=torch.bfloat16) * 0.2)(D, N)
        B_im = (lambda *s: torch.randn(*s, dtype=torch.bfloat16) * 0.2)(D, N)
        C_re = (lambda *s: torch.randn(*s, dtype=torch.bfloat16) * 0.2)(D, N)
        C_im = (lambda *s: torch.randn(*s, dtype=torch.bfloat16) * 0.2)(D, N)
        log_dt = (lambda *s: torch.randn(*s, dtype=torch.bfloat16) * 0.1)(D) * 0.5 - 4.0
        Dskip = (lambda *s: torch.randn(*s, dtype=torch.bfloat16) * 0.1)(D)
        return {
            "u": _w((lambda *s: torch.randn(*s, dtype=torch.bfloat16) * 0.05)(B, L, D)),
            "A_re": _w(A_re),
            "A_im": _w(A_im),
            "B_re": _w(B_re),
            "B_im": _w(B_im),
            "C_re": _w(C_re),
            "C_im": _w(C_im),
            "log_dt": _w(log_dt),
            "Dskip": _w(Dskip),
        }
    _A_in = _A_setup()

    def _B_setup():
        B, S, D, Dff = 1, 2048, 640, 1536
        return {
            "x": _w((lambda *s: torch.randn(*s, dtype=torch.bfloat16) * 0.05)(B, S, D)),
            "w1": _w((lambda *s: torch.randn(*s, dtype=torch.bfloat16) * 0.05)(D, Dff)),
            "w2": _w((lambda *s: torch.randn(*s, dtype=torch.bfloat16) * 0.05)(Dff, D)),
        }
    _B_in = _B_setup()

    return {
        "A_u": _A_in["u"],
        "A_A_re": _A_in["A_re"],
        "A_A_im": _A_in["A_im"],
        "A_B_re": _A_in["B_re"],
        "A_B_im": _A_in["B_im"],
        "A_C_re": _A_in["C_re"],
        "A_C_im": _A_in["C_im"],
        "A_log_dt": _A_in["log_dt"],
        "A_Dskip": _A_in["Dskip"],
        "B_x": _B_in["x"],
        "B_w1": _B_in["w1"],
        "B_w2": _B_in["w2"],
        "gate_w": _w((lambda *s: torch.randn(*s, dtype=torch.bfloat16) * 0.05)(640) * 16.0),
    }

def reference(A_u, A_A_re, A_A_im, A_B_re, A_B_im, A_C_re, A_C_im, A_log_dt, A_Dskip, B_x, B_w1, B_w2, gate_w):
    def _A_ref(u, A_re, A_im, B_re, B_im, C_re, C_im, log_dt, Dskip):
        Bsz, L, D = u.shape
        dt = torch.exp(log_dt)[:, None]
        A = A_re + 1j * A_im
        Bc = B_re + 1j * B_im
        Cc = C_re + 1j * C_im
        logdA = dt * A
        dB = dt * Bc
        l = (lambda x, dt: x.to(dt))(torch.arange(L), A_re.dtype)
        P = torch.exp(logdA[:, :, None] * l[None, None, :])
        K = torch.einsum("dn,dnl,dn->dl", Cc, P, dB).real
        L2 = 2 * L
        Kp = _pad(K, ((0, 0), (0, L)))
        up = (lambda x, *d: x.permute(*d))(u, 0, 2, 1)
        up = _pad(up, ((0, 0), (0, 0), (0, L)))
        Kf = (lambda x, axes=(-2,-1): torch.fft.rfft2(x.float(), dim=axes))(Kp[:, None, :], axes=(-2, -1))
        Uf = (lambda x, axes=(-2,-1): torch.fft.rfft2(x.float(), dim=axes))(up[:, :, None, :], axes=(-2, -1))
        Yf = Uf * Kf[None, :, :, :]
        y = (lambda x, s, axes=(-2,-1): torch.fft.irfft2(x, s=s, dim=axes).to(torch.bfloat16))(Yf, (1, L2), axes=(-2, -1))[:, :, 0, :L]
        y = (lambda x, *d: x.permute(*d))(y, 0, 2, 1) + u * Dskip[None, None, :]
        return y

    def _B_ref(x, w1, w2):
        h = torch.einsum("bsd,df->bsf", x, w1)
        zero = torch.zeros_like(h)
        h = torch.maximum(h, zero)
        return torch.einsum("bsf,fd->bsd", h, w2)

    x = A_u
    g = _sigmoid((x * gate_w).sum(-1, keepdims=True))
    a = _A_ref(x, A_A_re, A_A_im, A_B_re, A_B_im, A_C_re, A_C_im, A_log_dt, A_Dskip)
    b = _B_ref(x, B_w1, B_w2)
    return g * a + (1 - g) * b
```

```asm
; @launch grid=(512,1,1) block=(256,1,1) lds=81920
.amdgcn_target "amdgcn-amd-amdhsa--gfx950"
.text
.globl gated_mix__ssm_conv_s4__dense_activation_relu__prompt_kernel
.p2align 8
.type gated_mix__ssm_conv_s4__dense_activation_relu__prompt_kernel,@function
gated_mix__ssm_conv_s4__dense_activation_relu__prompt_kernel:
    s_cmp_ge_u32 s2, 512
    s_cbranch_scc1 Lexit
    s_load_dwordx16 s[16:31], s[0:1], 0
    s_load_dwordx16 s[32:47], s[0:1], 64
    v_lshrrev_b32 v2, 6, v0
    v_and_b32 v1, 63, v0
    v_readfirstlane_b32 s3, v2
    s_cmp_lt_u32 s2, 256
    s_cbranch_scc1 LC
    s_setprio 3
    s_and_b32 s5, s2, 7
    s_bfe_u32 s6, s2, 0x50003
    s_and_b32 s7, s6, 3
    s_lshr_b32 s8, s6, 2
    s_lshr_b32 s9, s5, 1
    s_lshl_b32 s9, s9, 2
    s_add_u32 s9, s9, s7
    s_and_b32 s13, s5, 1
    s_lshl_b32 s10, s13, 3
    s_add_u32 s10, s10, s8
    s_lshl_b32 s11, s5, 2
    s_add_u32 s11, s11, s7
    s_add_u32 s12, s7, s8
    s_and_b32 s12, s12, 1
    s_mul_i32 s12, s12, 5
    s_lshl_b32 s13, s9, 2
    s_add_u32 s13, s13, s3
    s_mul_i32 s74, s13, 40960
    s_add_u32 s75, s74, 1280
    s_lshl_b32 s13, s12, 7
    s_add_u32 s72, s74, s13
    s_mul_i32 s76, s10, 192
    s_add_u32 s77, s76, 1966080
    s_mul_i32 s13, s12, 196608
    s_add_u32 s73, s76, s13
    s_lshl_b32 s78, s3, 12
    s_mul_i32 s79, s3, 3072
    s_add_u32 s79, s79, 32768
    v_lshrrev_b32 v3, 3, v1
    v_mul_u32_u24 v3, 1280, v3
    v_and_b32 v4, 7, v1
    v_lshrrev_b32 v5, 4, v1
    v_xor_b32 v4, v4, v5
    v_lshl_add_u32 v140, v4, 4, v3
    v_xor_b32 v4, 4, v4
    v_lshl_add_u32 v141, v4, 4, v3
    v_add_u32 v141, 9216, v141
    v_add_u32 v142, 18432, v140
    v_add_u32 v143, 18432, v141
    s_mul_i32 s13, s3, 192
    v_add_u32 v3, s13, v1
    v_add_u32 v3, 0, v3
    v_mul_u32_u24 v4, 5462, v3
    v_lshrrev_b32 v4, 16, v4
    v_mul_u32_u24 v5, 12, v4
    v_sub_u32 v5, v3, v5
    v_mul_u32_u24 v4, 3072, v4
    v_lshl_add_u32 v144, v5, 4, v4
    v_add_u32 v3, s13, v1
    v_add_u32 v3, 64, v3
    v_mul_u32_u24 v4, 5462, v3
    v_lshrrev_b32 v4, 16, v4
    v_mul_u32_u24 v5, 12, v4
    v_sub_u32 v5, v3, v5
    v_mul_u32_u24 v4, 3072, v4
    v_lshl_add_u32 v145, v5, 4, v4
    v_subrev_u32 v145, 1024, v145
    v_add_u32 v3, s13, v1
    v_add_u32 v3, 128, v3
    v_mul_u32_u24 v4, 5462, v3
    v_lshrrev_b32 v4, 16, v4
    v_mul_u32_u24 v5, 12, v4
    v_sub_u32 v5, v3, v5
    v_mul_u32_u24 v4, 3072, v4
    v_lshl_add_u32 v146, v5, 4, v4
    v_subrev_u32 v146, 2048, v146
    s_waitcnt lgkmcnt(0)
    s_mov_b32 s48, s16
    s_mov_b32 s49, s17
    s_mov_b32 s50, 2621440
    s_mov_b32 s51, 0x20000
    s_mov_b32 s52, s36
    s_mov_b32 s53, s37
    s_mov_b32 s54, 1966080
    s_mov_b32 s55, 0x20000
    s_add_u32 m0, s79, 0
    s_nop 0
    buffer_load_dwordx4 v144, s[52:55], s73 offen  lds
    buffer_load_dwordx4 v145, s[52:55], s73 offen offset:1024  lds
    buffer_load_dwordx4 v146, s[52:55], s73 offen offset:2048  lds
    s_add_u32 s73, s73, 196608
    s_cmp_eq_u32 s73, s77
    s_cselect_b32 s73, s76, s73
    s_add_u32 m0, s78, 0
    s_nop 0
    buffer_load_dwordx4 v140, s[48:51], s72 offen  lds
    buffer_load_dwordx4 v141, s[48:51], s72 offen offset:1024  lds
    buffer_load_dwordx4 v142, s[48:51], s72 offen offset:2048  lds
    buffer_load_dwordx4 v143, s[48:51], s72 offen offset:3072  lds
    s_add_u32 s72, s72, 128
    s_cmp_eq_u32 s72, s75
    s_cselect_b32 s72, s74, s72
    s_mov_b32 s56, s46
    s_mov_b32 s57, s47
    s_mov_b32 s58, 16777216
    s_mov_b32 s59, 0x20000
    s_mov_b32 s96, s46
    s_mov_b32 s97, s47
    s_load_dword s4, s[46:47], 0
    s_mov_b32 s60, s42
    s_mov_b32 s61, s43
    s_mov_b32 s62, 2621440
    s_mov_b32 s63, 0x20000
    s_mov_b32 s64, s40
    s_mov_b32 s65, s41
    s_mov_b32 s66, 1280
    s_mov_b32 s67, 0x20000
    v_and_b32 v3, 31, v1
    v_lshrrev_b32 v4, 1, v3
    v_and_b32 v4, 7, v4
    v_lshrrev_b32 v5, 5, v1
    v_xor_b32 v4, v4, v5
    v_lshlrev_b32 v3, 7, v3
    v_add_u32 v3, s78, v3
    v_xor_b32 v6, 0, v4
    v_lshl_add_u32 v147, v6, 4, v3
    v_xor_b32 v6, 2, v4
    v_lshl_add_u32 v148, v6, 4, v3
    v_xor_b32 v6, 4, v4
    v_lshl_add_u32 v149, v6, 4, v3
    v_xor_b32 v6, 6, v4
    v_lshl_add_u32 v150, v6, 4, v3
    v_lshrrev_b32 v5, 5, v1
    v_lshlrev_b32 v3, 3, v5
    v_bfe_u32 v4, v1, 2, 2
    v_add_u32 v3, v3, v4
    v_mul_u32_u24 v3, 192, v3
    v_bfe_u32 v4, v1, 4, 1
    v_lshl_add_u32 v3, v4, 5, v3
    v_and_b32 v4, 3, v1
    v_lshl_add_u32 v3, v4, 3, v3
    v_add_u32 v151, 32768, v3
    v_lshlrev_b32 v2, 4, v1
    s_and_b32 s70, s8, 3
    s_mul_i32 s70, s70, 3
    s_mul_i32 s6, s11, 48
    s_mul_i32 s7, s3, 12
    s_add_u32 s6, s6, s7
    s_lshl_b32 s6, s6, 12
    s_add_u32 s68, s6, 9437184
    s_mul_i32 s13, s8, 48
    s_add_u32 s7, s7, s13
    s_mul_i32 s7, s7, 5120
    s_add_u32 s69, s7, 1048576
    s_mul_i32 s5, s70, 5120
    s_lshl_b32 s13, s9, 2
    s_add_u32 s13, s13, s3
    s_lshl_b32 s13, s13, 4
    s_add_u32 s13, s13, s10
    s_lshl_b32 s14, s13, 4
    s_add_u32 s71, s14, 131072
    s_mul_i32 s12, s13, 2560
    v_mul_u32_u24 v5, 40, v1
    v_and_b32 v4, 31, v1
    v_mul_u32_u24 v6, 40, v4
    s_lshl_b32 s14, s8, 5
    s_add_u32 s14, s14, s11
    s_lshl_b32 s14, s14, 2
    s_add_u32 s14, s14, s3
    s_lshl_b32 s14, s14, 5
    s_add_u32 s24, s14, 32768
    s_add_u32 m0, s79, 12288
    s_nop 0
    buffer_load_dwordx4 v144, s[52:55], s73 offen  lds
    buffer_load_dwordx4 v145, s[52:55], s73 offen offset:1024  lds
    buffer_load_dwordx4 v146, s[52:55], s73 offen offset:2048  lds
    s_add_u32 s73, s73, 196608
    s_cmp_eq_u32 s73, s77
    s_cselect_b32 s73, s76, s73
    s_add_u32 m0, s78, 16384
    s_nop 0
    buffer_load_dwordx4 v140, s[48:51], s72 offen  lds
    buffer_load_dwordx4 v141, s[48:51], s72 offen offset:1024  lds
    buffer_load_dwordx4 v142, s[48:51], s72 offen offset:2048  lds
    buffer_load_dwordx4 v143, s[48:51], s72 offen offset:3072  lds
    s_add_u32 s72, s72, 128
    s_cmp_eq_u32 s72, s75
    s_cselect_b32 s72, s74, s72
    s_add_u32 m0, s79, 24576
    s_nop 0
    buffer_load_dwordx4 v144, s[52:55], s73 offen  lds
    buffer_load_dwordx4 v145, s[52:55], s73 offen offset:1024  lds
    buffer_load_dwordx4 v146, s[52:55], s73 offen offset:2048  lds
    s_add_u32 s73, s73, 196608
    s_cmp_eq_u32 s73, s77
    s_cselect_b32 s73, s76, s73
    s_waitcnt vmcnt(10)
    ds_read_b128 v[224:227], v147 offset:0
    ds_read_b128 v[228:231], v148 offset:0
    ds_read_b128 v[232:235], v149 offset:0
    ds_read_b128 v[236:239], v150 offset:0
    s_barrier
    ds_read_b64_tr_b16 v[152:153], v151 offset:0
    ds_read_b64_tr_b16 v[154:155], v151 offset:768
    ds_read_b64_tr_b16 v[156:157], v151 offset:64
    ds_read_b64_tr_b16 v[158:159], v151 offset:832
    ds_read_b64_tr_b16 v[160:161], v151 offset:128
    ds_read_b64_tr_b16 v[162:163], v151 offset:896
    ds_read_b64_tr_b16 v[164:165], v151 offset:3072
    ds_read_b64_tr_b16 v[166:167], v151 offset:3840
    ds_read_b64_tr_b16 v[168:169], v151 offset:3136
    ds_read_b64_tr_b16 v[170:171], v151 offset:3904
    ds_read_b64_tr_b16 v[172:173], v151 offset:3200
    ds_read_b64_tr_b16 v[174:175], v151 offset:3968
    s_waitcnt lgkmcnt(10)
    v_mfma_f32_32x32x16_bf16 v[176:191], v[152:155], v[224:227], 0
    ds_read_b64_tr_b16 v[152:153], v151 offset:6144
    ds_read_b64_tr_b16 v[154:155], v151 offset:6912
    s_add_u32 m0, s78, 0
    s_nop 0
    buffer_load_dwordx4 v140, s[48:51], s72 offen  lds
    s_waitcnt lgkmcnt(10)
    v_mfma_f32_32x32x16_bf16 v[192:207], v[156:159], v[224:227], 0
    ds_read_b64_tr_b16 v[156:157], v151 offset:6208
    ds_read_b64_tr_b16 v[158:159], v151 offset:6976
    buffer_load_dwordx4 v141, s[48:51], s72 offen offset:1024  lds
    s_waitcnt lgkmcnt(10)
    v_mfma_f32_32x32x16_bf16 v[208:223], v[160:163], v[224:227], 0
    ds_read_b64_tr_b16 v[160:161], v151 offset:6272
    ds_read_b64_tr_b16 v[162:163], v151 offset:7040
    buffer_load_dwordx4 v142, s[48:51], s72 offen offset:2048  lds
    s_waitcnt lgkmcnt(10)
    v_mfma_f32_32x32x16_bf16 v[176:191], v[164:167], v[228:231], v[176:191]
    s_waitcnt vmcnt(6)
    s_barrier
    ds_read_b64_tr_b16 v[164:165], v151 offset:9216
    ds_read_b64_tr_b16 v[166:167], v151 offset:9984
    ds_read_b128 v[240:243], v147 offset:16384
    buffer_load_dwordx4 v143, s[48:51], s72 offen offset:3072  lds
    s_add_u32 s72, s72, 128
    s_cmp_eq_u32 s72, s75
    s_cselect_b32 s72, s74, s72
    s_waitcnt lgkmcnt(11)
    v_mfma_f32_32x32x16_bf16 v[192:207], v[168:171], v[228:231], v[192:207]
    ds_read_b64_tr_b16 v[168:169], v151 offset:9280
    ds_read_b64_tr_b16 v[170:171], v151 offset:10048
    ds_read_b128 v[244:247], v148 offset:16384
    s_waitcnt lgkmcnt(12)
    v_mfma_f32_32x32x16_bf16 v[208:223], v[172:175], v[228:231], v[208:223]
    ds_read_b64_tr_b16 v[172:173], v151 offset:9344
    ds_read_b64_tr_b16 v[174:175], v151 offset:10112
    ds_read_b128 v[248:251], v149 offset:16384
    s_add_u32 m0, s79, 36864
    s_nop 0
    buffer_load_dwordx4 v144, s[52:55], s73 offen  lds
    s_waitcnt lgkmcnt(13)
    v_mfma_f32_32x32x16_bf16 v[176:191], v[152:155], v[232:235], v[176:191]
    ds_read_b64_tr_b16 v[152:153], v151 offset:12288
    ds_read_b64_tr_b16 v[154:155], v151 offset:13056
    ds_read_b128 v[252:255], v150 offset:16384
    s_waitcnt lgkmcnt(14)
    v_mfma_f32_32x32x16_bf16 v[192:207], v[156:159], v[232:235], v[192:207]
    ds_read_b64_tr_b16 v[156:157], v151 offset:12352
    ds_read_b64_tr_b16 v[158:159], v151 offset:13120
    buffer_load_dwordx4 v145, s[52:55], s73 offen offset:1024  lds
    s_waitcnt lgkmcnt(14)
    v_mfma_f32_32x32x16_bf16 v[208:223], v[160:163], v[232:235], v[208:223]
    ds_read_b64_tr_b16 v[160:161], v151 offset:12416
    ds_read_b64_tr_b16 v[162:163], v151 offset:13184
    s_waitcnt lgkmcnt(14)
    v_mfma_f32_32x32x16_bf16 v[176:191], v[164:167], v[236:239], v[176:191]
    ds_read_b64_tr_b16 v[164:165], v151 offset:15360
    ds_read_b64_tr_b16 v[166:167], v151 offset:16128
    buffer_load_dwordx4 v146, s[52:55], s73 offen offset:2048  lds
    s_add_u32 s73, s73, 196608
    s_cmp_eq_u32 s73, s77
    s_cselect_b32 s73, s76, s73
    s_waitcnt lgkmcnt(13)
    v_mfma_f32_32x32x16_bf16 v[192:207], v[168:171], v[236:239], v[192:207]
    ds_read_b64_tr_b16 v[168:169], v151 offset:15424
    ds_read_b64_tr_b16 v[170:171], v151 offset:16192
    s_waitcnt lgkmcnt(12)
    v_mfma_f32_32x32x16_bf16 v[208:223], v[172:175], v[236:239], v[208:223]
    ds_read_b64_tr_b16 v[172:173], v151 offset:15488
    ds_read_b64_tr_b16 v[174:175], v151 offset:16256
    s_waitcnt lgkmcnt(10)
    v_mfma_f32_32x32x16_bf16 v[176:191], v[152:155], v[240:243], v[176:191]
    ds_read_b64_tr_b16 v[152:153], v151 offset:18432
    ds_read_b64_tr_b16 v[154:155], v151 offset:19200
    s_add_u32 m0, s78, 16384
    s_nop 0
    buffer_load_dwordx4 v140, s[48:51], s72 offen  lds
    s_waitcnt lgkmcnt(10)
    v_mfma_f32_32x32x16_bf16 v[192:207], v[156:159], v[240:243], v[192:207]
    ds_read_b64_tr_b16 v[156:157], v151 offset:18496
    ds_read_b64_tr_b16 v[158:159], v151 offset:19264
    buffer_load_dwordx4 v141, s[48:51], s72 offen offset:1024  lds
    s_waitcnt lgkmcnt(10)
    v_mfma_f32_32x32x16_bf16 v[208:223], v[160:163], v[240:243], v[208:223]
    ds_read_b64_tr_b16 v[160:161], v151 offset:18560
    ds_read_b64_tr_b16 v[162:163], v151 offset:19328
    buffer_load_dwordx4 v142, s[48:51], s72 offen offset:2048  lds
    s_waitcnt lgkmcnt(10)
    v_mfma_f32_32x32x16_bf16 v[176:191], v[164:167], v[244:247], v[176:191]
    s_waitcnt vmcnt(6)
    s_barrier
    ds_read_b64_tr_b16 v[164:165], v151 offset:21504
    ds_read_b64_tr_b16 v[166:167], v151 offset:22272
    ds_read_b128 v[224:227], v147 offset:0
    buffer_load_dwordx4 v143, s[48:51], s72 offen offset:3072  lds
    s_add_u32 s72, s72, 128
    s_cmp_eq_u32 s72, s75
    s_cselect_b32 s72, s74, s72
    s_waitcnt lgkmcnt(11)
    v_mfma_f32_32x32x16_bf16 v[192:207], v[168:171], v[244:247], v[192:207]
    ds_read_b64_tr_b16 v[168:169], v151 offset:21568
    ds_read_b64_tr_b16 v[170:171], v151 offset:22336
    ds_read_b128 v[228:231], v148 offset:0
    s_waitcnt lgkmcnt(12)
    v_mfma_f32_32x32x16_bf16 v[208:223], v[172:175], v[244:247], v[208:223]
    ds_read_b64_tr_b16 v[172:173], v151 offset:21632
    ds_read_b64_tr_b16 v[174:175], v151 offset:22400
    ds_read_b128 v[232:235], v149 offset:0
    s_add_u32 m0, s79, 0
    s_nop 0
    buffer_load_dwordx4 v144, s[52:55], s73 offen  lds
    s_waitcnt lgkmcnt(13)
    v_mfma_f32_32x32x16_bf16 v[176:191], v[152:155], v[248:251], v[176:191]
    ds_read_b64_tr_b16 v[152:153], v151 offset:24576
    ds_read_b64_tr_b16 v[154:155], v151 offset:25344
    ds_read_b128 v[236:239], v150 offset:0
    s_waitcnt lgkmcnt(14)
    v_mfma_f32_32x32x16_bf16 v[192:207], v[156:159], v[248:251], v[192:207]
    ds_read_b64_tr_b16 v[156:157], v151 offset:24640
    ds_read_b64_tr_b16 v[158:159], v151 offset:25408
    buffer_load_dwordx4 v145, s[52:55], s73 offen offset:1024  lds
    s_waitcnt lgkmcnt(14)
    v_mfma_f32_32x32x16_bf16 v[208:223], v[160:163], v[248:251], v[208:223]
    ds_read_b64_tr_b16 v[160:161], v151 offset:24704
    ds_read_b64_tr_b16 v[162:163], v151 offset:25472
    s_waitcnt lgkmcnt(14)
    v_mfma_f32_32x32x16_bf16 v[176:191], v[164:167], v[252:255], v[176:191]
    ds_read_b64_tr_b16 v[164:165], v151 offset:27648
    ds_read_b64_tr_b16 v[166:167], v151 offset:28416
    buffer_load_dwordx4 v146, s[52:55], s73 offen offset:2048  lds
    s_add_u32 s73, s73, 196608
    s_cmp_eq_u32 s73, s77
    s_cselect_b32 s73, s76, s73
    s_waitcnt lgkmcnt(13)
    v_mfma_f32_32x32x16_bf16 v[192:207], v[168:171], v[252:255], v[192:207]
    ds_read_b64_tr_b16 v[168:169], v151 offset:27712
    ds_read_b64_tr_b16 v[170:171], v151 offset:28480
    s_waitcnt lgkmcnt(12)
    v_mfma_f32_32x32x16_bf16 v[208:223], v[172:175], v[252:255], v[208:223]
    ds_read_b64_tr_b16 v[172:173], v151 offset:27776
    ds_read_b64_tr_b16 v[174:175], v151 offset:28544
    s_waitcnt lgkmcnt(10)
    v_mfma_f32_32x32x16_bf16 v[176:191], v[152:155], v[224:227], v[176:191]
    ds_read_b64_tr_b16 v[152:153], v151 offset:30720
    ds_read_b64_tr_b16 v[154:155], v151 offset:31488
    s_add_u32 m0, s78, 0
    s_nop 0
    buffer_load_dwordx4 v140, s[48:51], s72 offen  lds
    s_waitcnt lgkmcnt(10)
    v_mfma_f32_32x32x16_bf16 v[192:207], v[156:159], v[224:227], v[192:207]
    ds_read_b64_tr_b16 v[156:157], v151 offset:30784
    ds_read_b64_tr_b16 v[158:159], v151 offset:31552
    buffer_load_dwordx4 v141, s[48:51], s72 offen offset:1024  lds
    s_waitcnt lgkmcnt(10)
    v_mfma_f32_32x32x16_bf16 v[208:223], v[160:163], v[224:227], v[208:223]
    ds_read_b64_tr_b16 v[160:161], v151 offset:30848
    ds_read_b64_tr_b16 v[162:163], v151 offset:31616
    buffer_load_dwordx4 v142, s[48:51], s72 offen offset:2048  lds
    s_waitcnt lgkmcnt(10)
    v_mfma_f32_32x32x16_bf16 v[176:191], v[164:167], v[228:231], v[176:191]
    s_waitcnt vmcnt(6)
    s_barrier
    ds_read_b64_tr_b16 v[164:165], v151 offset:33792
    ds_read_b64_tr_b16 v[166:167], v151 offset:34560
    ds_read_b128 v[240:243], v147 offset:16384
    buffer_load_dwordx4 v143, s[48:51], s72 offen offset:3072  lds
    s_add_u32 s72, s72, 128
    s_cmp_eq_u32 s72, s75
    s_cselect_b32 s72, s74, s72
    s_waitcnt lgkmcnt(11)
    v_mfma_f32_32x32x16_bf16 v[192:207], v[168:171], v[228:231], v[192:207]
    ds_read_b64_tr_b16 v[168:169], v151 offset:33856
    ds_read_b64_tr_b16 v[170:171], v151 offset:34624
    ds_read_b128 v[244:247], v148 offset:16384
    s_waitcnt lgkmcnt(12)
    v_mfma_f32_32x32x16_bf16 v[208:223], v[172:175], v[228:231], v[208:223]
    ds_read_b64_tr_b16 v[172:173], v151 offset:33920
    ds_read_b64_tr_b16 v[174:175], v151 offset:34688
    ds_read_b128 v[248:251], v149 offset:16384
    s_add_u32 m0, s79, 12288
    s_nop 0
    buffer_load_dwordx4 v144, s[52:55], s73 offen  lds
    s_waitcnt lgkmcnt(13)
    v_mfma_f32_32x32x16_bf16 v[176:191], v[152:155], v[232:235], v[176:191]
    ds_read_b64_tr_b16 v[152:153], v151 offset:36864
    ds_read_b64_tr_b16 v[154:155], v151 offset:37632
    ds_read_b128 v[252:255], v150 offset:16384
    s_waitcnt lgkmcnt(14)
    v_mfma_f32_32x32x16_bf16 v[192:207], v[156:159], v[232:235], v[192:207]
    ds_read_b64_tr_b16 v[156:157], v151 offset:36928
    ds_read_b64_tr_b16 v[158:159], v151 offset:37696
    buffer_load_dwordx4 v145, s[52:55], s73 offen offset:1024  lds
    s_waitcnt lgkmcnt(14)
    v_mfma_f32_32x32x16_bf16 v[208:223], v[160:163], v[232:235], v[208:223]
    ds_read_b64_tr_b16 v[160:161], v151 offset:36992
    ds_read_b64_tr_b16 v[162:163], v151 offset:37760
    s_waitcnt lgkmcnt(14)
    v_mfma_f32_32x32x16_bf16 v[176:191], v[164:167], v[236:239], v[176:191]
    ds_read_b64_tr_b16 v[164:165], v151 offset:39936
    ds_read_b64_tr_b16 v[166:167], v151 offset:40704
    buffer_load_dwordx4 v146, s[52:55], s73 offen offset:2048  lds
    s_add_u32 s73, s73, 196608
    s_cmp_eq_u32 s73, s77
    s_cselect_b32 s73, s76, s73
    s_waitcnt lgkmcnt(13)
    v_mfma_f32_32x32x16_bf16 v[192:207], v[168:171], v[236:239], v[192:207]
    ds_read_b64_tr_b16 v[168:169], v151 offset:40000
    ds_read_b64_tr_b16 v[170:171], v151 offset:40768
    s_waitcnt lgkmcnt(12)
    v_mfma_f32_32x32x16_bf16 v[208:223], v[172:175], v[236:239], v[208:223]
    ds_read_b64_tr_b16 v[172:173], v151 offset:40064
    ds_read_b64_tr_b16 v[174:175], v151 offset:40832
    s_waitcnt lgkmcnt(10)
    v_mfma_f32_32x32x16_bf16 v[176:191], v[152:155], v[240:243], v[176:191]
    ds_read_b64_tr_b16 v[152:153], v151 offset:43008
    ds_read_b64_tr_b16 v[154:155], v151 offset:43776
    s_add_u32 m0, s78, 16384
    s_nop 0
    buffer_load_dwordx4 v140, s[48:51], s72 offen  lds
    s_waitcnt lgkmcnt(10)
    v_mfma_f32_32x32x16_bf16 v[192:207], v[156:159], v[240:243], v[192:207]
    ds_read_b64_tr_b16 v[156:157], v151 offset:43072
    ds_read_b64_tr_b16 v[158:159], v151 offset:43840
    buffer_load_dwordx4 v141, s[48:51], s72 offen offset:1024  lds
    s_waitcnt lgkmcnt(10)
    v_mfma_f32_32x32x16_bf16 v[208:223], v[160:163], v[240:243], v[208:223]
    ds_read_b64_tr_b16 v[160:161], v151 offset:43136
    ds_read_b64_tr_b16 v[162:163], v151 offset:43904
    buffer_load_dwordx4 v142, s[48:51], s72 offen offset:2048  lds
    s_waitcnt lgkmcnt(10)
    v_mfma_f32_32x32x16_bf16 v[176:191], v[164:167], v[244:247], v[176:191]
    s_waitcnt vmcnt(6)
    s_barrier
    ds_read_b64_tr_b16 v[164:165], v151 offset:46080
    ds_read_b64_tr_b16 v[166:167], v151 offset:46848
    ds_read_b128 v[224:227], v147 offset:0
    buffer_load_dwordx4 v143, s[48:51], s72 offen offset:3072  lds
    s_add_u32 s72, s72, 128
    s_cmp_eq_u32 s72, s75
    s_cselect_b32 s72, s74, s72
    s_waitcnt lgkmcnt(11)
    v_mfma_f32_32x32x16_bf16 v[192:207], v[168:171], v[244:247], v[192:207]
    ds_read_b64_tr_b16 v[168:169], v151 offset:46144
    ds_read_b64_tr_b16 v[170:171], v151 offset:46912
    ds_read_b128 v[228:231], v148 offset:0
    s_waitcnt lgkmcnt(12)
    v_mfma_f32_32x32x16_bf16 v[208:223], v[172:175], v[244:247], v[208:223]
    ds_read_b64_tr_b16 v[172:173], v151 offset:46208
    ds_read_b64_tr_b16 v[174:175], v151 offset:46976
    ds_read_b128 v[232:235], v149 offset:0
    s_add_u32 m0, s79, 24576
    s_nop 0
    buffer_load_dwordx4 v144, s[52:55], s73 offen  lds
    s_waitcnt lgkmcnt(13)
    v_mfma_f32_32x32x16_bf16 v[176:191], v[152:155], v[248:251], v[176:191]
    ds_read_b64_tr_b16 v[152:153], v151 offset:0
    ds_read_b64_tr_b16 v[154:155], v151 offset:768
    ds_read_b128 v[236:239], v150 offset:0
    s_waitcnt lgkmcnt(14)
    v_mfma_f32_32x32x16_bf16 v[192:207], v[156:159], v[248:251], v[192:207]
    ds_read_b64_tr_b16 v[156:157], v151 offset:64
    ds_read_b64_tr_b16 v[158:159], v151 offset:832
    buffer_load_dwordx4 v145, s[52:55], s73 offen offset:1024  lds
    s_waitcnt lgkmcnt(14)
    v_mfma_f32_32x32x16_bf16 v[208:223], v[160:163], v[248:251], v[208:223]
    ds_read_b64_tr_b16 v[160:161], v151 offset:128
    ds_read_b64_tr_b16 v[162:163], v151 offset:896
    s_waitcnt lgkmcnt(14)
    v_mfma_f32_32x32x16_bf16 v[176:191], v[164:167], v[252:255], v[176:191]
    ds_read_b64_tr_b16 v[164:165], v151 offset:3072
    ds_read_b64_tr_b16 v[166:167], v151 offset:3840
    buffer_load_dwordx4 v146, s[52:55], s73 offen offset:2048  lds
    s_add_u32 s73, s73, 196608
    s_cmp_eq_u32 s73, s77
    s_cselect_b32 s73, s76, s73
    s_waitcnt lgkmcnt(13)
    v_mfma_f32_32x32x16_bf16 v[192:207], v[168:171], v[252:255], v[192:207]
    ds_read_b64_tr_b16 v[168:169], v151 offset:3136
    ds_read_b64_tr_b16 v[170:171], v151 offset:3904
    s_waitcnt lgkmcnt(12)
    v_mfma_f32_32x32x16_bf16 v[208:223], v[172:175], v[252:255], v[208:223]
    ds_read_b64_tr_b16 v[172:173], v151 offset:3200
    ds_read_b64_tr_b16 v[174:175], v151 offset:3968
    s_waitcnt lgkmcnt(10)
    v_mfma_f32_32x32x16_bf16 v[176:191], v[152:155], v[224:227], v[176:191]
    ds_read_b64_tr_b16 v[152:153], v151 offset:6144
    ds_read_b64_tr_b16 v[154:155], v151 offset:6912
    s_add_u32 m0, s78, 0
    s_nop 0
    buffer_load_dwordx4 v140, s[48:51], s72 offen  lds
    s_waitcnt lgkmcnt(10)
    v_mfma_f32_32x32x16_bf16 v[192:207], v[156:159], v[224:227], v[192:207]
    ds_read_b64_tr_b16 v[156:157], v151 offset:6208
    ds_read_b64_tr_b16 v[158:159], v151 offset:6976
    buffer_load_dwordx4 v141, s[48:51], s72 offen offset:1024  lds
    s_waitcnt lgkmcnt(10)
    v_mfma_f32_32x32x16_bf16 v[208:223], v[160:163], v[224:227], v[208:223]
    ds_read_b64_tr_b16 v[160:161], v151 offset:6272
    ds_read_b64_tr_b16 v[162:163], v151 offset:7040
    buffer_load_dwordx4 v142, s[48:51], s72 offen offset:2048  lds
    s_waitcnt lgkmcnt(10)
    v_mfma_f32_32x32x16_bf16 v[176:191], v[164:167], v[228:231], v[176:191]
    s_waitcnt vmcnt(6)
    s_barrier
    ds_read_b64_tr_b16 v[164:165], v151 offset:9216
    ds_read_b64_tr_b16 v[166:167], v151 offset:9984
    ds_read_b128 v[240:243], v147 offset:16384
    buffer_load_dwordx4 v143, s[48:51], s72 offen offset:3072  lds
    s_add_u32 s72, s72, 128
    s_cmp_eq_u32 s72, s75
    s_cselect_b32 s72, s74, s72
    s_waitcnt lgkmcnt(11)
    v_mfma_f32_32x32x16_bf16 v[192:207], v[168:171], v[228:231], v[192:207]
    ds_read_b64_tr_b16 v[168:169], v151 offset:9280
    ds_read_b64_tr_b16 v[170:171], v151 offset:10048
    ds_read_b128 v[244:247], v148 offset:16384
    s_waitcnt lgkmcnt(12)
    v_mfma_f32_32x32x16_bf16 v[208:223], v[172:175], v[228:231], v[208:223]
    ds_read_b64_tr_b16 v[172:173], v151 offset:9344
    ds_read_b64_tr_b16 v[174:175], v151 offset:10112
    ds_read_b128 v[248:251], v149 offset:16384
    s_add_u32 m0, s79, 36864
    s_nop 0
    buffer_load_dwordx4 v144, s[52:55], s73 offen  lds
    s_waitcnt lgkmcnt(13)
    v_mfma_f32_32x32x16_bf16 v[176:191], v[152:155], v[232:235], v[176:191]
    ds_read_b64_tr_b16 v[152:153], v151 offset:12288
    ds_read_b64_tr_b16 v[154:155], v151 offset:13056
    ds_read_b128 v[252:255], v150 offset:16384
    s_waitcnt lgkmcnt(14)
    v_mfma_f32_32x32x16_bf16 v[192:207], v[156:159], v[232:235], v[192:207]
    ds_read_b64_tr_b16 v[156:157], v151 offset:12352
    ds_read_b64_tr_b16 v[158:159], v151 offset:13120
    buffer_load_dwordx4 v145, s[52:55], s73 offen offset:1024  lds
    s_waitcnt lgkmcnt(14)
    v_mfma_f32_32x32x16_bf16 v[208:223], v[160:163], v[232:235], v[208:223]
    ds_read_b64_tr_b16 v[160:161], v151 offset:12416
    ds_read_b64_tr_b16 v[162:163], v151 offset:13184
    s_waitcnt lgkmcnt(14)
    v_mfma_f32_32x32x16_bf16 v[176:191], v[164:167], v[236:239], v[176:191]
    ds_read_b64_tr_b16 v[164:165], v151 offset:15360
    ds_read_b64_tr_b16 v[166:167], v151 offset:16128
    buffer_load_dwordx4 v146, s[52:55], s73 offen offset:2048  lds
    s_add_u32 s73, s73, 196608
    s_cmp_eq_u32 s73, s77
    s_cselect_b32 s73, s76, s73
    s_waitcnt lgkmcnt(13)
    v_mfma_f32_32x32x16_bf16 v[192:207], v[168:171], v[236:239], v[192:207]
    ds_read_b64_tr_b16 v[168:169], v151 offset:15424
    ds_read_b64_tr_b16 v[170:171], v151 offset:16192
    s_waitcnt lgkmcnt(12)
    v_mfma_f32_32x32x16_bf16 v[208:223], v[172:175], v[236:239], v[208:223]
    ds_read_b64_tr_b16 v[172:173], v151 offset:15488
    ds_read_b64_tr_b16 v[174:175], v151 offset:16256
    s_waitcnt lgkmcnt(10)
    v_mfma_f32_32x32x16_bf16 v[176:191], v[152:155], v[240:243], v[176:191]
    ds_read_b64_tr_b16 v[152:153], v151 offset:18432
    ds_read_b64_tr_b16 v[154:155], v151 offset:19200
    s_add_u32 m0, s78, 16384
    s_nop 0
    buffer_load_dwordx4 v140, s[48:51], s72 offen  lds
    s_waitcnt lgkmcnt(10)
    v_mfma_f32_32x32x16_bf16 v[192:207], v[156:159], v[240:243], v[192:207]
    ds_read_b64_tr_b16 v[156:157], v151 offset:18496
    ds_read_b64_tr_b16 v[158:159], v151 offset:19264
    buffer_load_dwordx4 v141, s[48:51], s72 offen offset:1024  lds
    s_waitcnt lgkmcnt(10)
    v_mfma_f32_32x32x16_bf16 v[208:223], v[160:163], v[240:243], v[208:223]
    ds_read_b64_tr_b16 v[160:161], v151 offset:18560
    ds_read_b64_tr_b16 v[162:163], v151 offset:19328
    buffer_load_dwordx4 v142, s[48:51], s72 offen offset:2048  lds
    s_waitcnt lgkmcnt(10)
    v_mfma_f32_32x32x16_bf16 v[176:191], v[164:167], v[244:247], v[176:191]
    s_waitcnt vmcnt(6)
    s_barrier
    s_load_dwordx8 s[16:23], s[96:97], s24 glc
    ds_read_b64_tr_b16 v[164:165], v151 offset:21504
    ds_read_b64_tr_b16 v[166:167], v151 offset:22272
    ds_read_b128 v[224:227], v147 offset:0
    buffer_load_dwordx4 v143, s[48:51], s72 offen offset:3072  lds
    s_add_u32 s72, s72, 128
    s_cmp_eq_u32 s72, s75
    s_cselect_b32 s72, s74, s72
    s_waitcnt lgkmcnt(11)
    v_mfma_f32_32x32x16_bf16 v[192:207], v[168:171], v[244:247], v[192:207]
    ds_read_b64_tr_b16 v[168:169], v151 offset:21568
    ds_read_b64_tr_b16 v[170:171], v151 offset:22336
    ds_read_b128 v[228:231], v148 offset:0
    s_waitcnt lgkmcnt(12)
    v_mfma_f32_32x32x16_bf16 v[208:223], v[172:175], v[244:247], v[208:223]
    ds_read_b64_tr_b16 v[172:173], v151 offset:21632
    ds_read_b64_tr_b16 v[174:175], v151 offset:22400
    ds_read_b128 v[232:235], v149 offset:0
    s_add_u32 m0, s79, 0
    s_nop 0
    buffer_load_dwordx4 v144, s[52:55], s73 offen  lds
    s_waitcnt lgkmcnt(13)
    v_mfma_f32_32x32x16_bf16 v[176:191], v[152:155], v[248:251], v[176:191]
    ds_read_b64_tr_b16 v[152:153], v151 offset:24576
    ds_read_b64_tr_b16 v[154:155], v151 offset:25344
    ds_read_b128 v[236:239], v150 offset:0
    s_waitcnt lgkmcnt(14)
    v_mfma_f32_32x32x16_bf16 v[192:207], v[156:159], v[248:251], v[192:207]
    ds_read_b64_tr_b16 v[156:157], v151 offset:24640
    ds_read_b64_tr_b16 v[158:159], v151 offset:25408
    buffer_load_dwordx4 v145, s[52:55], s73 offen offset:1024  lds
    s_waitcnt lgkmcnt(14)
    v_mfma_f32_32x32x16_bf16 v[208:223], v[160:163], v[248:251], v[208:223]
    ds_read_b64_tr_b16 v[160:161], v151 offset:24704
    ds_read_b64_tr_b16 v[162:163], v151 offset:25472
    s_waitcnt lgkmcnt(14)
    v_mfma_f32_32x32x16_bf16 v[176:191], v[164:167], v[252:255], v[176:191]
    ds_read_b64_tr_b16 v[164:165], v151 offset:27648
    ds_read_b64_tr_b16 v[166:167], v151 offset:28416
    buffer_load_dwordx4 v146, s[52:55], s73 offen offset:2048  lds
    s_add_u32 s73, s73, 196608
    s_cmp_eq_u32 s73, s77
    s_cselect_b32 s73, s76, s73
    s_waitcnt lgkmcnt(13)
    v_mfma_f32_32x32x16_bf16 v[192:207], v[168:171], v[252:255], v[192:207]
    ds_read_b64_tr_b16 v[168:169], v151 offset:27712
    ds_read_b64_tr_b16 v[170:171], v151 offset:28480
    s_waitcnt lgkmcnt(12)
    v_mfma_f32_32x32x16_bf16 v[208:223], v[172:175], v[252:255], v[208:223]
    ds_read_b64_tr_b16 v[172:173], v151 offset:27776
    ds_read_b64_tr_b16 v[174:175], v151 offset:28544
    s_waitcnt lgkmcnt(10)
    v_mfma_f32_32x32x16_bf16 v[176:191], v[152:155], v[224:227], v[176:191]
    ds_read_b64_tr_b16 v[152:153], v151 offset:30720
    ds_read_b64_tr_b16 v[154:155], v151 offset:31488
    s_add_u32 m0, s78, 0
    s_nop 0
    buffer_load_dwordx4 v140, s[48:51], s72 offen  lds
    s_waitcnt lgkmcnt(10)
    v_mfma_f32_32x32x16_bf16 v[192:207], v[156:159], v[224:227], v[192:207]
    ds_read_b64_tr_b16 v[156:157], v151 offset:30784
    ds_read_b64_tr_b16 v[158:159], v151 offset:31552
    buffer_load_dwordx4 v141, s[48:51], s72 offen offset:1024  lds
    s_waitcnt lgkmcnt(10)
    v_mfma_f32_32x32x16_bf16 v[208:223], v[160:163], v[224:227], v[208:223]
    ds_read_b64_tr_b16 v[160:161], v151 offset:30848
    ds_read_b64_tr_b16 v[162:163], v151 offset:31616
    buffer_load_dwordx4 v142, s[48:51], s72 offen offset:2048  lds
    s_waitcnt lgkmcnt(10)
    v_mfma_f32_32x32x16_bf16 v[176:191], v[164:167], v[228:231], v[176:191]
    s_waitcnt vmcnt(6)
    s_waitcnt lgkmcnt(0)
    s_add_u32 s4, s4, 1
    s_barrier
    s_mov_b32 s15, 20000
    s_branch Lsc_3
Lsp_1:
    s_load_dwordx8 s[16:23], s[96:97], s24 glc
    s_waitcnt lgkmcnt(0)
Lsc_3:
    s_xor_b32 s16, s16, s4
    s_xor_b32 s17, s17, s4
    s_xor_b32 s18, s18, s4
    s_xor_b32 s19, s19, s4
    s_xor_b32 s20, s20, s4
    s_xor_b32 s21, s21, s4
    s_or_b32 s16, s16, s17
    s_or_b32 s16, s16, s18
    s_or_b32 s16, s16, s19
    s_or_b32 s16, s16, s20
    s_or_b32 s16, s16, s21
    s_cbranch_scc0 Lsd_2
    s_setprio 0
    s_sleep 2
    s_sub_u32 s15, s15, 1
    s_cbranch_scc0 Lsp_1
Lsd_2:
    s_setprio 3
    ds_read_b64_tr_b16 v[164:165], v151 offset:33792
    ds_read_b64_tr_b16 v[166:167], v151 offset:34560
    ds_read_b128 v[240:243], v147 offset:16384
    buffer_load_dwordx4 v143, s[48:51], s72 offen offset:3072  lds
    s_add_u32 s72, s72, 128
    s_cmp_eq_u32 s72, s75
    s_cselect_b32 s72, s74, s72
    s_waitcnt lgkmcnt(11)
    v_mfma_f32_32x32x16_bf16 v[192:207], v[168:171], v[228:231], v[192:207]
    ds_read_b64_tr_b16 v[168:169], v151 offset:33856
    ds_read_b64_tr_b16 v[170:171], v151 offset:34624
    ds_read_b128 v[244:247], v148 offset:16384
    s_waitcnt lgkmcnt(12)
    v_mfma_f32_32x32x16_bf16 v[208:223], v[172:175], v[228:231], v[208:223]
    ds_read_b64_tr_b16 v[172:173], v151 offset:33920
    ds_read_b64_tr_b16 v[174:175], v151 offset:34688
    ds_read_b128 v[248:251], v149 offset:16384
    s_add_u32 m0, s79, 12288
    s_nop 0
    buffer_load_dwordx4 v144, s[52:55], s73 offen  lds
    s_waitcnt lgkmcnt(13)
    v_mfma_f32_32x32x16_bf16 v[176:191], v[152:155], v[232:235], v[176:191]
    ds_read_b64_tr_b16 v[152:153], v151 offset:36864
    ds_read_b64_tr_b16 v[154:155], v151 offset:37632
    ds_read_b128 v[252:255], v150 offset:16384
    s_waitcnt lgkmcnt(14)
    v_mfma_f32_32x32x16_bf16 v[192:207], v[156:159], v[232:235], v[192:207]
    ds_read_b64_tr_b16 v[156:157], v151 offset:36928
    ds_read_b64_tr_b16 v[158:159], v151 offset:37696
    buffer_load_dwordx4 v145, s[52:55], s73 offen offset:1024  lds
    s_waitcnt lgkmcnt(14)
    v_mfma_f32_32x32x16_bf16 v[208:223], v[160:163], v[232:235], v[208:223]
    ds_read_b64_tr_b16 v[160:161], v151 offset:36992
    ds_read_b64_tr_b16 v[162:163], v151 offset:37760
    s_waitcnt lgkmcnt(14)
    v_mfma_f32_32x32x16_bf16 v[176:191], v[164:167], v[236:239], v[176:191]
    ds_read_b64_tr_b16 v[164:165], v151 offset:39936
    ds_read_b64_tr_b16 v[166:167], v151 offset:40704
    buffer_load_dwordx4 v146, s[52:55], s73 offen offset:2048  lds
    s_add_u32 s73, s73, 196608
    s_cmp_eq_u32 s73, s77
    s_cselect_b32 s73, s76, s73
    s_waitcnt lgkmcnt(13)
    v_mfma_f32_32x32x16_bf16 v[192:207], v[168:171], v[236:239], v[192:207]
    ds_read_b64_tr_b16 v[168:169], v151 offset:40000
    ds_read_b64_tr_b16 v[170:171], v151 offset:40768
    s_waitcnt lgkmcnt(12)
    v_mfma_f32_32x32x16_bf16 v[208:223], v[172:175], v[236:239], v[208:223]
    ds_read_b64_tr_b16 v[172:173], v151 offset:40064
    ds_read_b64_tr_b16 v[174:175], v151 offset:40832
    s_waitcnt lgkmcnt(10)
    v_mfma_f32_32x32x16_bf16 v[176:191], v[152:155], v[240:243], v[176:191]
    ds_read_b64_tr_b16 v[152:153], v151 offset:43008
    ds_read_b64_tr_b16 v[154:155], v151 offset:43776
    s_add_u32 m0, s78, 16384
    s_nop 0
    buffer_load_dwordx4 v140, s[48:51], s72 offen  lds
    s_waitcnt lgkmcnt(10)
    v_mfma_f32_32x32x16_bf16 v[192:207], v[156:159], v[240:243], v[192:207]
    ds_read_b64_tr_b16 v[156:157], v151 offset:43072
    ds_read_b64_tr_b16 v[158:159], v151 offset:43840
    buffer_load_dwordx4 v141, s[48:51], s72 offen offset:1024  lds
    s_waitcnt lgkmcnt(10)
    v_mfma_f32_32x32x16_bf16 v[208:223], v[160:163], v[240:243], v[208:223]
    ds_read_b64_tr_b16 v[160:161], v151 offset:43136
    ds_read_b64_tr_b16 v[162:163], v151 offset:43904
    buffer_load_dwordx4 v142, s[48:51], s72 offen offset:2048  lds
    s_waitcnt lgkmcnt(10)
    v_mfma_f32_32x32x16_bf16 v[176:191], v[164:167], v[244:247], v[176:191]
    s_waitcnt vmcnt(6)
    s_barrier
    ds_read_b64_tr_b16 v[164:165], v151 offset:46080
    ds_read_b64_tr_b16 v[166:167], v151 offset:46848
    ds_read_b128 v[224:227], v147 offset:0
    buffer_load_dwordx4 v143, s[48:51], s72 offen offset:3072  lds
    s_add_u32 s72, s72, 128
    s_cmp_eq_u32 s72, s75
    s_cselect_b32 s72, s74, s72
    s_waitcnt lgkmcnt(11)
    v_mfma_f32_32x32x16_bf16 v[192:207], v[168:171], v[244:247], v[192:207]
    ds_read_b64_tr_b16 v[168:169], v151 offset:46144
    ds_read_b64_tr_b16 v[170:171], v151 offset:46912
    ds_read_b128 v[228:231], v148 offset:0
    s_add_u32 s25, s5, 0
    s_cmp_ge_u32 s25, 61440
    s_cselect_b32 s15, 61440, 0
    s_sub_u32 s25, s25, s15
    s_add_u32 s25, s25, s69
    buffer_load_dwordx4 v[8:11], v2, s[56:59], s25 offen offset:0 sc1
    s_waitcnt lgkmcnt(12)
    v_mfma_f32_32x32x16_bf16 v[208:223], v[172:175], v[244:247], v[208:223]
    ds_read_b64_tr_b16 v[172:173], v151 offset:46208
    ds_read_b64_tr_b16 v[174:175], v151 offset:46976
    ds_read_b128 v[232:235], v149 offset:0
    s_waitcnt lgkmcnt(13)
    v_mfma_f32_32x32x16_bf16 v[176:191], v[152:155], v[248:251], v[176:191]
    ds_read_b64_tr_b16 v[152:153], v151 offset:0
    ds_read_b64_tr_b16 v[154:155], v151 offset:768
    ds_read_b128 v[236:239], v150 offset:0
    buffer_load_dwordx4 v[12:15], v2, s[56:59], s25 offen offset:1024 sc1
    s_waitcnt lgkmcnt(14)
    v_mfma_f32_32x32x16_bf16 v[192:207], v[156:159], v[248:251], v[192:207]
    ds_read_b64_tr_b16 v[156:157], v151 offset:64
    ds_read_b64_tr_b16 v[158:159], v151 offset:832
    s_waitcnt lgkmcnt(14)
    v_mfma_f32_32x32x16_bf16 v[208:223], v[160:163], v[248:251], v[208:223]
    ds_read_b64_tr_b16 v[160:161], v151 offset:128
    ds_read_b64_tr_b16 v[162:163], v151 offset:896
    buffer_load_dwordx4 v[16:19], v2, s[56:59], s25 offen offset:2048 sc1
    s_waitcnt lgkmcnt(14)
    v_mfma_f32_32x32x16_bf16 v[176:191], v[164:167], v[252:255], v[176:191]
    ds_read_b64_tr_b16 v[164:165], v151 offset:3072
    ds_read_b64_tr_b16 v[166:167], v151 offset:3840
    s_waitcnt lgkmcnt(13)
    v_mfma_f32_32x32x16_bf16 v[192:207], v[168:171], v[252:255], v[192:207]
    ds_read_b64_tr_b16 v[168:169], v151 offset:3136
    ds_read_b64_tr_b16 v[170:171], v151 offset:3904
    buffer_load_dwordx4 v[20:23], v2, s[56:59], s25 offen offset:3072 sc1
    s_waitcnt lgkmcnt(12)
    v_mfma_f32_32x32x16_bf16 v[208:223], v[172:175], v[252:255], v[208:223]
    ds_read_b64_tr_b16 v[172:173], v151 offset:3200
    ds_read_b64_tr_b16 v[174:175], v151 offset:3968
    s_waitcnt lgkmcnt(10)
    v_mfma_f32_32x32x16_bf16 v[176:191], v[152:155], v[224:227], v[176:191]
    ds_read_b64_tr_b16 v[152:153], v151 offset:6144
    ds_read_b64_tr_b16 v[154:155], v151 offset:6912
    buffer_load_dwordx4 v[108:111], v5, s[48:51], s12 offen
    s_lshl_b32 s13, s9, 1
    s_lshr_b32 s6, s3, 1
    s_add_u32 s13, s13, s6
    s_waitcnt lgkmcnt(10)
    v_mfma_f32_32x32x16_bf16 v[192:207], v[156:159], v[224:227], v[192:207]
    ds_read_b64_tr_b16 v[156:157], v151 offset:6208
    ds_read_b64_tr_b16 v[158:159], v151 offset:6976
    buffer_load_dwordx4 v[112:115], v5, s[48:51], s12 offen offset:16
    s_lshl_b32 s7, s13, 5
    s_lshr_b32 s6, s10, 2
    s_add_u32 s7, s7, s6
    s_waitcnt lgkmcnt(10)
    v_mfma_f32_32x32x16_bf16 v[208:223], v[160:163], v[224:227], v[208:223]
    ds_read_b64_tr_b16 v[160:161], v151 offset:6272
    ds_read_b64_tr_b16 v[162:163], v151 offset:7040
    buffer_load_dwordx2 v[116:117], v5, s[48:51], s12 offen offset:32
    s_lshl_b32 s7, s7, 5
    s_mul_i32 s13, s13, 48
    s_mul_i32 s6, s10, 3
    s_waitcnt lgkmcnt(10)
    v_mfma_f32_32x32x16_bf16 v[176:191], v[164:167], v[228:231], v[176:191]
    s_waitcnt vmcnt(7)
    s_barrier
    ds_read_b64_tr_b16 v[164:165], v151 offset:9216
    ds_read_b64_tr_b16 v[166:167], v151 offset:9984
    ds_read_b128 v[240:243], v147 offset:16384
    buffer_load_dwordx2 v[118:119], v6, s[64:67], 0 offen
    s_add_u32 s13, s13, s6
    s_lshl_b32 s13, s13, 12
    s_and_b32 s6, s3, 1
    s_waitcnt lgkmcnt(11)
    v_mfma_f32_32x32x16_bf16 v[192:207], v[168:171], v[228:231], v[192:207]
    ds_read_b64_tr_b16 v[168:169], v151 offset:9280
    ds_read_b64_tr_b16 v[170:171], v151 offset:10048
    ds_read_b128 v[244:247], v148 offset:16384
    buffer_load_dwordx4 v[120:123], v6, s[64:67], 0 offen offset:8
    s_lshl_b32 s14, s6, 2
    s_add_u32 s7, s7, s14
    s_lshl_b32 s6, s6, 11
    s_waitcnt lgkmcnt(12)
    v_mfma_f32_32x32x16_bf16 v[208:223], v[172:175], v[228:231], v[208:223]
    ds_read_b64_tr_b16 v[172:173], v151 offset:9344
    ds_read_b64_tr_b16 v[174:175], v151 offset:10112
    ds_read_b128 v[248:251], v149 offset:16384
    buffer_load_dwordx4 v[124:127], v6, s[64:67], 0 offen offset:24
    s_add_u32 s13, s13, s6
    s_add_u32 s13, s13, 9437184
    s_and_b32 s6, s10, 3
    s_waitcnt lgkmcnt(13)
    v_mfma_f32_32x32x16_bf16 v[176:191], v[152:155], v[232:235], v[176:191]
    ds_read_b64_tr_b16 v[152:153], v151 offset:12288
    ds_read_b64_tr_b16 v[154:155], v151 offset:13056
    ds_read_b128 v[252:255], v150 offset:16384
    s_add_u32 s25, s25, 4096
    buffer_load_dwordx4 v[24:27], v2, s[56:59], s25 offen offset:0 sc1
    s_lshl_b32 s6, s6, 3
    s_add_u32 s7, s7, s6
    s_add_u32 s7, s7, 98304
    s_waitcnt lgkmcnt(14)
    v_mfma_f32_32x32x16_bf16 v[192:207], v[156:159], v[232:235], v[192:207]
    ds_read_b64_tr_b16 v[156:157], v151 offset:15360
    ds_read_b64_tr_b16 v[158:159], v151 offset:16128
    v_bfe_u32 v3, v1, 4, 1
    v_lshlrev_b32 v3, 10, v3
    v_lshrrev_b32 v4, 5, v1
    s_waitcnt lgkmcnt(14)
    v_mfma_f32_32x32x16_bf16 v[208:223], v[160:163], v[232:235], v[208:223]
    ds_read_b64_tr_b16 v[160:161], v151 offset:18432
    ds_read_b64_tr_b16 v[162:163], v151 offset:19200
    s_add_u32 s25, s5, 5120
    s_cmp_ge_u32 s25, 61440
    s_cselect_b32 s15, 61440, 0
    s_sub_u32 s25, s25, s15
    s_add_u32 s25, s25, s69
    buffer_load_dwordx4 v[28:31], v2, s[56:59], s25 offen offset:0 sc1
    v_lshl_add_u32 v3, v4, 9, v3
    v_and_b32 v4, 15, v1
    v_lshl_add_u32 v3, v4, 4, v3
    s_waitcnt lgkmcnt(14)
    v_mfma_f32_32x32x16_bf16 v[176:191], v[164:167], v[236:239], v[176:191]
    ds_read_b64_tr_b16 v[164:165], v151 offset:21504
    ds_read_b64_tr_b16 v[166:167], v151 offset:22272
    s_waitcnt lgkmcnt(13)
    v_mfma_f32_32x32x16_bf16 v[192:207], v[168:171], v[236:239], v[192:207]
    ds_read_b64_tr_b16 v[168:169], v151 offset:12352
    ds_read_b64_tr_b16 v[170:171], v151 offset:13120
    buffer_load_dwordx4 v[32:35], v2, s[56:59], s25 offen offset:1024 sc1
    s_waitcnt lgkmcnt(12)
    v_mfma_f32_32x32x16_bf16 v[208:223], v[172:175], v[236:239], v[208:223]
    ds_read_b64_tr_b16 v[172:173], v151 offset:15424
    ds_read_b64_tr_b16 v[174:175], v151 offset:16192
    s_waitcnt lgkmcnt(10)
    v_mfma_f32_32x32x16_bf16 v[176:191], v[152:155], v[240:243], v[176:191]
    ds_read_b64_tr_b16 v[152:153], v151 offset:18496
    ds_read_b64_tr_b16 v[154:155], v151 offset:19264
    buffer_load_dwordx4 v[36:39], v2, s[56:59], s25 offen offset:2048 sc1
    s_waitcnt lgkmcnt(10)
    v_mfma_f32_32x32x16_bf16 v[176:191], v[156:159], v[244:247], v[176:191]
    ds_read_b64_tr_b16 v[156:157], v151 offset:21568
    ds_read_b64_tr_b16 v[158:159], v151 offset:22336
    s_waitcnt lgkmcnt(10)
    v_mfma_f32_32x32x16_bf16 v[176:191], v[160:163], v[248:251], v[176:191]
    ds_read_b64_tr_b16 v[160:161], v151 offset:12416
    ds_read_b64_tr_b16 v[162:163], v151 offset:13184
    buffer_load_dwordx4 v[40:43], v2, s[56:59], s25 offen offset:3072 sc1
    s_waitcnt lgkmcnt(10)
    v_mfma_f32_32x32x16_bf16 v[176:191], v[164:167], v[252:255], v[176:191]
    ds_read_b64_tr_b16 v[164:165], v151 offset:15488
    ds_read_b64_tr_b16 v[166:167], v151 offset:16256
    s_waitcnt lgkmcnt(10)
    v_mfma_f32_32x32x16_bf16 v[192:207], v[168:171], v[240:243], v[192:207]
    ds_read_b64_tr_b16 v[168:169], v151 offset:18560
    ds_read_b64_tr_b16 v[170:171], v151 offset:19328
    s_add_u32 s25, s25, 4096
    buffer_load_dwordx4 v[44:47], v2, s[56:59], s25 offen offset:0 sc1
    s_waitcnt lgkmcnt(10)
    v_mfma_f32_32x32x16_bf16 v[192:207], v[172:175], v[244:247], v[192:207]
    ds_read_b64_tr_b16 v[172:173], v151 offset:21632
    ds_read_b64_tr_b16 v[174:175], v151 offset:22400
    v_cvt_pk_bf16_f32 v128, v176, v177
    v_cvt_pk_bf16_f32 v129, v178, v179
    v_cvt_pk_bf16_f32 v130, v180, v181
    v_cvt_pk_bf16_f32 v131, v182, v183
    v_pk_max_i16 v128, v128, 0
    s_waitcnt lgkmcnt(10)
    v_mfma_f32_32x32x16_bf16 v[192:207], v[152:155], v[248:251], v[192:207]
    v_pk_max_i16 v129, v129, 0
    v_pk_max_i16 v130, v130, 0
    v_pk_max_i16 v131, v131, 0
    buffer_store_dwordx4 v[128:131], v3, s[56:59], s13 offen offset:0 sc1
    v_cvt_pk_bf16_f32 v132, v184, v185
    s_waitcnt lgkmcnt(8)
    v_mfma_f32_32x32x16_bf16 v[192:207], v[156:159], v[252:255], v[192:207]
    v_cvt_pk_bf16_f32 v133, v186, v187
    v_cvt_pk_bf16_f32 v134, v188, v189
    v_cvt_pk_bf16_f32 v135, v190, v191
    v_pk_max_i16 v132, v132, 0
    v_pk_max_i16 v133, v133, 0
    s_waitcnt lgkmcnt(6)
    v_mfma_f32_32x32x16_bf16 v[208:223], v[160:163], v[240:243], v[208:223]
    v_pk_max_i16 v134, v134, 0
    v_pk_max_i16 v135, v135, 0
    buffer_store_dwordx4 v[132:135], v3, s[56:59], s13 offen offset:256 sc1
    s_add_u32 s13, s13, 4096
    s_waitcnt lgkmcnt(4)
    v_mfma_f32_32x32x16_bf16 v[208:223], v[164:167], v[244:247], v[208:223]
    v_cvt_pk_bf16_f32 v136, v192, v193
    v_cvt_pk_bf16_f32 v137, v194, v195
    v_cvt_pk_bf16_f32 v138, v196, v197
    v_cvt_pk_bf16_f32 v139, v198, v199
    v_pk_max_i16 v136, v136, 0
    s_waitcnt lgkmcnt(2)
    v_mfma_f32_32x32x16_bf16 v[208:223], v[168:171], v[248:251], v[208:223]
    v_pk_max_i16 v137, v137, 0
    v_pk_max_i16 v138, v138, 0
    v_pk_max_i16 v139, v139, 0
    buffer_store_dwordx4 v[136:139], v3, s[56:59], s13 offen offset:0 sc1
    v_cvt_pk_bf16_f32 v140, v200, v201
    s_waitcnt lgkmcnt(0)
    s_barrier
    v_mfma_f32_32x32x16_bf16 v[208:223], v[172:175], v[252:255], v[208:223]
    v_cvt_pk_bf16_f32 v141, v202, v203
    v_cvt_pk_bf16_f32 v142, v204, v205
    v_cvt_pk_bf16_f32 v143, v206, v207
    v_pk_max_i16 v140, v140, 0
    v_pk_max_i16 v141, v141, 0
    v_pk_max_i16 v142, v142, 0
    v_pk_max_i16 v143, v143, 0
    buffer_store_dwordx4 v[140:143], v3, s[56:59], s13 offen offset:256 sc1
    s_add_u32 s13, s13, 4096
    s_nop 2
    v_cvt_pk_bf16_f32 v144, v208, v209
    v_cvt_pk_bf16_f32 v145, v210, v211
    v_cvt_pk_bf16_f32 v146, v212, v213
    v_cvt_pk_bf16_f32 v147, v214, v215
    v_pk_max_i16 v144, v144, 0
    v_pk_max_i16 v145, v145, 0
    v_pk_max_i16 v146, v146, 0
    v_pk_max_i16 v147, v147, 0
    buffer_store_dwordx4 v[144:147], v3, s[56:59], s13 offen offset:0 sc1
    v_cvt_pk_bf16_f32 v148, v216, v217
    v_cvt_pk_bf16_f32 v149, v218, v219
    v_cvt_pk_bf16_f32 v150, v220, v221
    v_cvt_pk_bf16_f32 v151, v222, v223
    v_pk_max_i16 v148, v148, 0
    v_pk_max_i16 v149, v149, 0
    v_pk_max_i16 v150, v150, 0
    v_pk_max_i16 v151, v151, 0
    buffer_store_dwordx4 v[148:151], v3, s[56:59], s13 offen offset:256 sc1
    s_setprio 1
    s_waitcnt vmcnt(3)
    v_mov_b32 v154, 0
    v_mov_b32 v155, 0
    s_mov_b32 s26, 0xffff0000
    v_lshlrev_b32 v156, 16, v108
    v_and_b32 v157, s26, v108
    v_lshlrev_b32 v158, 16, v118
    v_and_b32 v159, s26, v118
    v_lshlrev_b32 v160, 16, v109
    v_and_b32 v161, s26, v109
    v_lshlrev_b32 v162, 16, v119
    v_and_b32 v163, s26, v119
    s_add_u32 s25, s5, 10240
    s_cmp_ge_u32 s25, 61440
    s_cselect_b32 s15, 61440, 0
    s_sub_u32 s25, s25, s15
    s_add_u32 s25, s25, s69
    buffer_load_dwordx4 v[48:51], v2, s[56:59], s25 offen offset:0 sc1
    v_mul_f32 v156, v156, v158
    v_mul_f32 v157, v157, v159
    v_mul_f32 v160, v160, v162
    v_mul_f32 v161, v161, v163
    v_cvt_pk_bf16_f32 v156, 0, v156
    v_cvt_pk_bf16_f32 v157, 0, v157
    v_cvt_pk_bf16_f32 v160, 0, v160
    v_cvt_pk_bf16_f32 v161, 0, v161
    v_add_f32 v154, v154, v156
    v_add_f32 v155, v155, v157
    v_add_f32 v154, v154, v160
    buffer_load_dwordx4 v[52:55], v2, s[56:59], s25 offen offset:1024 sc1
    v_add_f32 v155, v155, v161
    v_lshlrev_b32 v156, 16, v110
    v_and_b32 v157, s26, v110
    v_lshlrev_b32 v158, 16, v120
    v_and_b32 v159, s26, v120
    v_lshlrev_b32 v160, 16, v111
    v_and_b32 v161, s26, v111
    v_lshlrev_b32 v162, 16, v121
    v_and_b32 v163, s26, v121
    v_mul_f32 v156, v156, v158
    v_mul_f32 v157, v157, v159
    buffer_load_dwordx4 v[56:59], v2, s[56:59], s25 offen offset:2048 sc1
    v_mul_f32 v160, v160, v162
    v_mul_f32 v161, v161, v163
    v_cvt_pk_bf16_f32 v156, 0, v156
    v_cvt_pk_bf16_f32 v157, 0, v157
    v_cvt_pk_bf16_f32 v160, 0, v160
    v_cvt_pk_bf16_f32 v161, 0, v161
    v_add_f32 v154, v154, v156
    v_add_f32 v155, v155, v157
    v_add_f32 v154, v154, v160
    v_add_f32 v155, v155, v161
    v_lshlrev_b32 v156, 16, v112
    buffer_load_dwordx4 v[60:63], v2, s[56:59], s25 offen offset:3072 sc1
    v_and_b32 v157, s26, v112
    v_lshlrev_b32 v158, 16, v122
    v_and_b32 v159, s26, v122
    v_lshlrev_b32 v160, 16, v113
    v_and_b32 v161, s26, v113
    v_lshlrev_b32 v162, 16, v123
    v_and_b32 v163, s26, v123
    v_mul_f32 v156, v156, v158
    v_mul_f32 v157, v157, v159
    v_mul_f32 v160, v160, v162
    v_mul_f32 v161, v161, v163
    s_add_u32 s25, s25, 4096
    buffer_load_dwordx4 v[64:67], v2, s[56:59], s25 offen offset:0 sc1
    v_cvt_pk_bf16_f32 v156, 0, v156
    v_cvt_pk_bf16_f32 v157, 0, v157
    v_cvt_pk_bf16_f32 v160, 0, v160
    v_cvt_pk_bf16_f32 v161, 0, v161
    v_add_f32 v154, v154, v156
    v_add_f32 v155, v155, v157
    v_add_f32 v154, v154, v160
    v_add_f32 v155, v155, v161
    v_lshlrev_b32 v156, 16, v114
    v_and_b32 v157, s26, v114
    v_lshlrev_b32 v158, 16, v124
    s_add_u32 s25, s5, 35840
    s_cmp_ge_u32 s25, 61440
    s_cselect_b32 s15, 61440, 0
    s_sub_u32 s25, s25, s15
    s_add_u32 s25, s25, s69
    buffer_load_dwordx4 v[68:71], v2, s[56:59], s25 offen offset:0 sc1
    v_and_b32 v159, s26, v124
    v_lshlrev_b32 v160, 16, v115
    v_and_b32 v161, s26, v115
    v_lshlrev_b32 v162, 16, v125
    v_and_b32 v163, s26, v125
    v_mul_f32 v156, v156, v158
    v_mul_f32 v157, v157, v159
    v_mul_f32 v160, v160, v162
    v_mul_f32 v161, v161, v163
    v_cvt_pk_bf16_f32 v156, 0, v156
    v_cvt_pk_bf16_f32 v157, 0, v157
    buffer_load_dwordx4 v[72:75], v2, s[56:59], s25 offen offset:1024 sc1
    v_cvt_pk_bf16_f32 v160, 0, v160
    v_cvt_pk_bf16_f32 v161, 0, v161
    v_add_f32 v154, v154, v156
    v_add_f32 v155, v155, v157
    v_add_f32 v154, v154, v160
    v_add_f32 v155, v155, v161
    v_lshlrev_b32 v156, 16, v116
    v_and_b32 v157, s26, v116
    v_lshlrev_b32 v158, 16, v126
    v_and_b32 v159, s26, v126
    v_lshlrev_b32 v160, 16, v117
    buffer_load_dwordx4 v[76:79], v2, s[56:59], s25 offen offset:2048 sc1
    v_and_b32 v161, s26, v117
    v_lshlrev_b32 v162, 16, v127
    v_and_b32 v163, s26, v127
    v_mul_f32 v156, v156, v158
    v_mul_f32 v157, v157, v159
    v_mul_f32 v160, v160, v162
    v_mul_f32 v161, v161, v163
    v_cvt_pk_bf16_f32 v156, 0, v156
    v_cvt_pk_bf16_f32 v157, 0, v157
    v_cvt_pk_bf16_f32 v160, 0, v160
    v_cvt_pk_bf16_f32 v161, 0, v161
    buffer_load_dwordx4 v[80:83], v2, s[56:59], s25 offen offset:3072 sc1
    v_add_f32 v154, v154, v156
    v_add_f32 v155, v155, v157
    v_add_f32 v154, v154, v160
    v_add_f32 v155, v155, v161
    v_add_f32 v154, v154, v155
    v_and_b32 v156, 31, v1
    v_lshrrev_b32 v157, 5, v1
    v_add_f32_dpp v154, v154, v154 row_shr:1 row_mask:0xf bank_mask:0xf bound_ctrl:0
    v_lshlrev_b32 v157, 3, v157
    v_cmp_eq_u32 vcc, 31, v156
    v_add_f32_dpp v154, v154, v154 row_shr:2 row_mask:0xf bank_mask:0xf bound_ctrl:0
    s_add_u32 s25, s25, 4096
    buffer_load_dwordx4 v[84:87], v2, s[56:59], s25 offen offset:0 sc1
    v_cndmask_b32 v157, -1, v157, vcc
    v_mov_b32 v155, s4
    v_add_f32_dpp v154, v154, v154 row_shr:4 row_mask:0xf bank_mask:0xf bound_ctrl:0
    s_nop 1
    v_add_f32_dpp v154, v154, v154 row_shr:8 row_mask:0xf bank_mask:0xf bound_ctrl:0
    s_nop 1
    v_add_f32_dpp v154, v154, v154 row_bcast:15 row_mask:0xa bank_mask:0xf
    v_cvt_pk_bf16_f32 v154, 0, v154
    v_mul_f32 v154, 0xbfb8aa3b, v154
    v_exp_f32 v154, v154
    s_nop 0
    v_add_f32 v154, 1.0, v154
    v_rcp_f32 v154, v154
    s_nop 0
    v_cvt_pk_bf16_f32 v154, 0, v154
    buffer_store_dwordx2 v[154:155], v157, s[56:59], s71 offen sc1
    s_waitcnt vmcnt(11)
    v_mov_b32 v4, s4
    v_mul_u32_u24 v5, 128, v1
    s_mov_b32 exec_lo, 0xff
    s_mov_b32 exec_hi, 0
    buffer_store_dword v4, v5, s[56:59], s7 offen sc1
    s_mov_b64 exec, -1
    s_add_u32 s25, s5, 40960
    s_cmp_ge_u32 s25, 61440
    s_cselect_b32 s15, 61440, 0
    s_sub_u32 s25, s25, s15
    s_add_u32 s25, s25, s69
    buffer_load_dwordx4 v[88:91], v2, s[56:59], s25 offen offset:0 sc1
    buffer_load_dwordx4 v[92:95], v2, s[56:59], s25 offen offset:1024 sc1
    buffer_load_dwordx4 v[96:99], v2, s[56:59], s25 offen offset:2048 sc1
    buffer_load_dwordx4 v[100:103], v2, s[56:59], s25 offen offset:3072 sc1
    s_add_u32 s25, s25, 4096
    buffer_load_dwordx4 v[104:107], v2, s[56:59], s25 offen offset:0 sc1
    s_add_u32 s14, s5, 15360
    s_cmp_ge_u32 s14, 61440
    s_cselect_b32 s15, 61440, 0
    s_sub_u32 s14, s14, s15
    s_add_u32 s14, s14, s69
    s_mul_i32 s6, s3, 15360
    s_add_u32 m0, s6, 0
    s_nop 0
    buffer_load_dwordx4 v2, s[56:59], s14 offen offset:0 sc1 lds
    buffer_load_dwordx4 v2, s[56:59], s14 offen offset:1024 sc1 lds
    buffer_load_dwordx4 v2, s[56:59], s14 offen offset:2048 sc1 lds
    buffer_load_dwordx4 v2, s[56:59], s14 offen offset:3072 sc1 lds
    s_add_u32 s14, s14, 4096
    s_add_u32 m0, m0, 4096
    s_nop 0
    buffer_load_dwordx4 v2, s[56:59], s14 offen offset:0 sc1 lds
    s_add_u32 s14, s5, 20480
    s_cmp_ge_u32 s14, 61440
    s_cselect_b32 s15, 61440, 0
    s_sub_u32 s14, s14, s15
    s_add_u32 s14, s14, s69
    s_mul_i32 s6, s3, 15360
    s_add_u32 m0, s6, 5120
    s_nop 0
    buffer_load_dwordx4 v2, s[56:59], s14 offen offset:0 sc1 lds
    buffer_load_dwordx4 v2, s[56:59], s14 offen offset:1024 sc1 lds
    buffer_load_dwordx4 v2, s[56:59], s14 offen offset:2048 sc1 lds
    buffer_load_dwordx4 v2, s[56:59], s14 offen offset:3072 sc1 lds
    s_add_u32 s14, s14, 4096
    s_add_u32 m0, m0, 4096
    s_nop 0
    buffer_load_dwordx4 v2, s[56:59], s14 offen offset:0 sc1 lds
    s_add_u32 s14, s5, 25600
    s_cmp_ge_u32 s14, 61440
    s_cselect_b32 s15, 61440, 0
    s_sub_u32 s14, s14, s15
    s_add_u32 s14, s14, s69
    s_mul_i32 s6, s3, 15360
    s_add_u32 m0, s6, 10240
    s_nop 0
    buffer_load_dwordx4 v2, s[56:59], s14 offen offset:0 sc1 lds
    buffer_load_dwordx4 v2, s[56:59], s14 offen offset:1024 sc1 lds
    buffer_load_dwordx4 v2, s[56:59], s14 offen offset:2048 sc1 lds
    buffer_load_dwordx4 v2, s[56:59], s14 offen offset:3072 sc1 lds
    s_add_u32 s14, s14, 4096
    s_add_u32 m0, m0, 4096
    s_nop 0
    buffer_load_dwordx4 v2, s[56:59], s14 offen offset:0 sc1 lds
    s_add_u32 s14, s5, 30720
    s_cmp_ge_u32 s14, 61440
    s_cselect_b32 s15, 61440, 0
    s_sub_u32 s14, s14, s15
    s_add_u32 s14, s14, s69
    s_mul_i32 s6, s3, 5120
    s_add_u32 m0, s6, 61440
    s_nop 0
    buffer_load_dwordx4 v2, s[56:59], s14 offen offset:0 sc1 lds
    buffer_load_dwordx4 v2, s[56:59], s14 offen offset:1024 sc1 lds
    buffer_load_dwordx4 v2, s[56:59], s14 offen offset:2048 sc1 lds
    buffer_load_dwordx4 v2, s[56:59], s14 offen offset:3072 sc1 lds
    s_add_u32 s14, s14, 4096
    s_add_u32 m0, m0, 4096
    s_nop 0
    buffer_load_dwordx4 v2, s[56:59], s14 offen offset:0 sc1 lds
    s_add_u32 s25, s5, 46080
    s_cmp_ge_u32 s25, 61440
    s_cselect_b32 s15, 61440, 0
    s_sub_u32 s25, s25, s15
    s_add_u32 s25, s25, s69
    buffer_load_dwordx4 v[108:111], v2, s[56:59], s25 offen offset:0 sc1
    buffer_load_dwordx4 v[112:115], v2, s[56:59], s25 offen offset:1024 sc1
    buffer_load_dwordx4 v[116:119], v2, s[56:59], s25 offen offset:2048 sc1
    buffer_load_dwordx4 v[120:123], v2, s[56:59], s25 offen offset:3072 sc1
    s_add_u32 s25, s25, 4096
    buffer_load_dwordx4 v[124:127], v2, s[56:59], s25 offen offset:0 sc1
    s_add_u32 s6, s3, 1
    s_and_b32 s6, s6, 3
    s_lshl_b32 s6, s6, 10
    v_add_u32 v4, s6, v2
    s_add_u32 s6, s3, 2
    s_and_b32 s6, s6, 3
    s_lshl_b32 s6, s6, 10
    v_add_u32 v5, s6, v2
    s_add_u32 s6, s3, 3
    s_and_b32 s6, s6, 3
    s_lshl_b32 s6, s6, 10
    v_add_u32 v6, s6, v2
    s_add_u32 s6, s3, 4
    s_and_b32 s6, s6, 3
    s_lshl_b32 s6, s6, 10
    v_add_u32 v7, s6, v2
    s_lshl_b32 s13, s70, 12
    s_add_u32 s72, s68, s13
    s_add_u32 s74, s68, 49152
    s_mul_i32 s6, s3, 15360
    v_add_u32 v3, s6, v2
    s_mul_i32 s6, s3, 5120
    s_add_u32 s6, s6, 61440
    v_add_u32 v0, s6, v2
    s_lshl_b32 s13, s11, 3
    s_add_u32 s13, s13, s8
    s_lshl_b32 s13, s13, 2
    s_add_u32 s13, s13, s3
    s_lshl_b32 s13, s13, 5
    s_add_u32 s13, s13, 98304
    s_mov_b32 s15, 20000
Lsp_4:
    s_load_dwordx8 s[16:23], s[96:97], s13 glc
    s_waitcnt lgkmcnt(0)
    s_xor_b32 s16, s16, s4
    s_xor_b32 s17, s17, s4
    s_xor_b32 s18, s18, s4
    s_xor_b32 s19, s19, s4
    s_xor_b32 s20, s20, s4
    s_xor_b32 s21, s21, s4
    s_xor_b32 s22, s22, s4
    s_xor_b32 s23, s23, s4
    s_or_b64 s[16:17], s[16:17], s[18:19]
    s_or_b64 s[16:17], s[16:17], s[20:21]
    s_or_b64 s[16:17], s[16:17], s[22:23]
    s_cbranch_scc0 Lsd_5
    s_setprio 0
    s_sleep 1
    s_sub_u32 s15, s15, 1
    s_cbranch_scc0 Lsp_4
Lsd_5:
    s_setprio 1
    buffer_load_dwordx4 v[128:131], v4, s[56:59], s72 offen sc1
    buffer_load_dwordx4 v[132:135], v5, s[56:59], s72 offen sc1
    buffer_load_dwordx4 v[136:139], v6, s[56:59], s72 offen sc1
    buffer_load_dwordx4 v[140:143], v7, s[56:59], s72 offen sc1
    s_add_u32 s72, s72, 4096
    s_cmp_eq_u32 s72, s74
    s_cselect_b32 s72, s68, s72
    buffer_load_dwordx4 v[144:147], v4, s[56:59], s72 offen sc1
    buffer_load_dwordx4 v[148:151], v5, s[56:59], s72 offen sc1
    buffer_load_dwordx4 v[152:155], v6, s[56:59], s72 offen sc1
    buffer_load_dwordx4 v[156:159], v7, s[56:59], s72 offen sc1
    s_add_u32 s72, s72, 4096
    s_cmp_eq_u32 s72, s74
    s_cselect_b32 s72, s68, s72
    buffer_load_dwordx4 v[160:163], v4, s[56:59], s72 offen sc1
    buffer_load_dwordx4 v[164:167], v5, s[56:59], s72 offen sc1
    buffer_load_dwordx4 v[168:171], v6, s[56:59], s72 offen sc1
    buffer_load_dwordx4 v[172:175], v7, s[56:59], s72 offen sc1
    s_add_u32 s72, s72, 4096
    s_cmp_eq_u32 s72, s74
    s_cselect_b32 s72, s68, s72
    s_waitcnt vmcnt(11)
    v_mfma_f32_16x16x32_bf16 v[176:179], v[8:11], v[128:131], 0
    s_waitcnt vmcnt(10)
    v_mfma_f32_16x16x32_bf16 v[196:199], v[8:11], v[132:135], 0
    s_waitcnt vmcnt(9)
    v_mfma_f32_16x16x32_bf16 v[216:219], v[8:11], v[136:139], 0
    s_waitcnt vmcnt(8)
    v_mfma_f32_16x16x32_bf16 v[236:239], v[8:11], v[140:143], 0
    buffer_load_dwordx4 v[8:11], v4, s[56:59], s72 offen sc1
    s_waitcnt vmcnt(63)
    v_mfma_f32_16x16x32_bf16 v[180:183], v[12:15], v[128:131], 0
    v_mfma_f32_16x16x32_bf16 v[200:203], v[12:15], v[132:135], 0
    v_mfma_f32_16x16x32_bf16 v[220:223], v[12:15], v[136:139], 0
    v_mfma_f32_16x16x32_bf16 v[240:243], v[12:15], v[140:143], 0
    buffer_load_dwordx4 v[12:15], v5, s[56:59], s72 offen sc1
    s_waitcnt vmcnt(63)
    v_mfma_f32_16x16x32_bf16 v[184:187], v[16:19], v[128:131], 0
    v_mfma_f32_16x16x32_bf16 v[204:207], v[16:19], v[132:135], 0
    v_mfma_f32_16x16x32_bf16 v[224:227], v[16:19], v[136:139], 0
    v_mfma_f32_16x16x32_bf16 v[244:247], v[16:19], v[140:143], 0
    buffer_load_dwordx4 v[16:19], v6, s[56:59], s72 offen sc1
    s_waitcnt vmcnt(63)
    v_mfma_f32_16x16x32_bf16 v[188:191], v[20:23], v[128:131], 0
    v_mfma_f32_16x16x32_bf16 v[208:211], v[20:23], v[132:135], 0
    v_mfma_f32_16x16x32_bf16 v[228:231], v[20:23], v[136:139], 0
    v_mfma_f32_16x16x32_bf16 v[248:251], v[20:23], v[140:143], 0
    buffer_load_dwordx4 v[20:23], v7, s[56:59], s72 offen sc1
    s_add_u32 s72, s72, 4096
    s_cmp_eq_u32 s72, s74
    s_cselect_b32 s72, s68, s72
    s_waitcnt vmcnt(63)
    v_mfma_f32_16x16x32_bf16 v[192:195], v[24:27], v[128:131], 0
    buffer_load_dwordx4 v[128:131], v4, s[56:59], s72 offen sc1
    v_mfma_f32_16x16x32_bf16 v[212:215], v[24:27], v[132:135], 0
    v_mfma_f32_16x16x32_bf16 v[232:235], v[24:27], v[136:139], 0
    v_mfma_f32_16x16x32_bf16 v[252:255], v[24:27], v[140:143], 0
    buffer_load_dwordx4 v[132:135], v5, s[56:59], s72 offen sc1
    s_waitcnt vmcnt(13)
    v_mfma_f32_16x16x32_bf16 v[176:179], v[28:31], v[144:147], v[176:179]
    s_waitcnt vmcnt(12)
    v_mfma_f32_16x16x32_bf16 v[196:199], v[28:31], v[148:151], v[196:199]
    s_waitcnt vmcnt(11)
    v_mfma_f32_16x16x32_bf16 v[216:219], v[28:31], v[152:155], v[216:219]
    buffer_load_dwordx4 v[136:139], v6, s[56:59], s72 offen sc1
    s_waitcnt vmcnt(11)
    v_mfma_f32_16x16x32_bf16 v[236:239], v[28:31], v[156:159], v[236:239]
    s_waitcnt vmcnt(63)
    v_mfma_f32_16x16x32_bf16 v[180:183], v[32:35], v[144:147], v[180:183]
    v_mfma_f32_16x16x32_bf16 v[200:203], v[32:35], v[148:151], v[200:203]
    v_mfma_f32_16x16x32_bf16 v[220:223], v[32:35], v[152:155], v[220:223]
    buffer_load_dwordx4 v[24:27], v7, s[56:59], s72 offen sc1
    s_add_u32 s72, s72, 4096
    s_cmp_eq_u32 s72, s74
    s_cselect_b32 s72, s68, s72
    v_mfma_f32_16x16x32_bf16 v[240:243], v[32:35], v[156:159], v[240:243]
    s_waitcnt vmcnt(63)
    v_mfma_f32_16x16x32_bf16 v[184:187], v[36:39], v[144:147], v[184:187]
    v_mfma_f32_16x16x32_bf16 v[204:207], v[36:39], v[148:151], v[204:207]
    buffer_load_dwordx4 v[140:143], v4, s[56:59], s72 offen sc1
    v_mfma_f32_16x16x32_bf16 v[224:227], v[36:39], v[152:155], v[224:227]
    v_mfma_f32_16x16x32_bf16 v[244:247], v[36:39], v[156:159], v[244:247]
    s_waitcnt vmcnt(63)
    v_mfma_f32_16x16x32_bf16 v[188:191], v[40:43], v[144:147], v[188:191]
    v_mfma_f32_16x16x32_bf16 v[208:211], v[40:43], v[148:151], v[208:211]
    buffer_load_dwordx4 v[28:31], v5, s[56:59], s72 offen sc1
    v_mfma_f32_16x16x32_bf16 v[228:231], v[40:43], v[152:155], v[228:231]
    v_mfma_f32_16x16x32_bf16 v[248:251], v[40:43], v[156:159], v[248:251]
    s_waitcnt vmcnt(63)
    v_mfma_f32_16x16x32_bf16 v[192:195], v[44:47], v[144:147], v[192:195]
    buffer_load_dwordx4 v[32:35], v6, s[56:59], s72 offen sc1
    v_mfma_f32_16x16x32_bf16 v[212:215], v[44:47], v[148:151], v[212:215]
    v_mfma_f32_16x16x32_bf16 v[232:235], v[44:47], v[152:155], v[232:235]
    v_mfma_f32_16x16x32_bf16 v[252:255], v[44:47], v[156:159], v[252:255]
    s_waitcnt vmcnt(14)
    v_mfma_f32_16x16x32_bf16 v[176:179], v[48:51], v[160:163], v[176:179]
    buffer_load_dwordx4 v[36:39], v7, s[56:59], s72 offen sc1
    s_add_u32 s72, s72, 4096
    s_cmp_eq_u32 s72, s74
    s_cselect_b32 s72, s68, s72
    s_waitcnt vmcnt(14)
    v_mfma_f32_16x16x32_bf16 v[196:199], v[48:51], v[164:167], v[196:199]
    s_waitcnt vmcnt(13)
    v_mfma_f32_16x16x32_bf16 v[216:219], v[48:51], v[168:171], v[216:219]
    s_waitcnt vmcnt(12)
    v_mfma_f32_16x16x32_bf16 v[236:239], v[48:51], v[172:175], v[236:239]
    s_waitcnt vmcnt(48)
    ds_read_b128 v[48:51], v3 offset:0
    buffer_load_dwordx4 v[40:43], v4, s[56:59], s72 offen sc1
    s_waitcnt vmcnt(63)
    v_mfma_f32_16x16x32_bf16 v[180:183], v[52:55], v[160:163], v[180:183]
    v_mfma_f32_16x16x32_bf16 v[200:203], v[52:55], v[164:167], v[200:203]
    v_mfma_f32_16x16x32_bf16 v[220:223], v[52:55], v[168:171], v[220:223]
    v_mfma_f32_16x16x32_bf16 v[240:243], v[52:55], v[172:175], v[240:243]
    s_waitcnt vmcnt(48)
    ds_read_b128 v[52:55], v3 offset:1024
    buffer_load_dwordx4 v[144:147], v5, s[56:59], s72 offen sc1
    s_waitcnt vmcnt(63)
    v_mfma_f32_16x16x32_bf16 v[184:187], v[56:59], v[160:163], v[184:187]
    v_mfma_f32_16x16x32_bf16 v[204:207], v[56:59], v[164:167], v[204:207]
    v_mfma_f32_16x16x32_bf16 v[224:227], v[56:59], v[168:171], v[224:227]
    buffer_load_dwordx4 v[148:151], v6, s[56:59], s72 offen sc1
    v_mfma_f32_16x16x32_bf16 v[244:247], v[56:59], v[172:175], v[244:247]
    s_waitcnt vmcnt(49)
    ds_read_b128 v[56:59], v3 offset:2048
    s_waitcnt vmcnt(63)
    v_mfma_f32_16x16x32_bf16 v[188:191], v[60:63], v[160:163], v[188:191]
    v_mfma_f32_16x16x32_bf16 v[208:211], v[60:63], v[164:167], v[208:211]
    v_mfma_f32_16x16x32_bf16 v[228:231], v[60:63], v[168:171], v[228:231]
    buffer_load_dwordx4 v[152:155], v7, s[56:59], s72 offen sc1
    s_add_u32 s72, s72, 4096
    s_cmp_eq_u32 s72, s74
    s_cselect_b32 s72, s68, s72
    v_mfma_f32_16x16x32_bf16 v[248:251], v[60:63], v[172:175], v[248:251]
    s_waitcnt vmcnt(49)
    ds_read_b128 v[60:63], v3 offset:3072
    s_waitcnt vmcnt(63)
    v_mfma_f32_16x16x32_bf16 v[192:195], v[64:67], v[160:163], v[192:195]
    v_mfma_f32_16x16x32_bf16 v[212:215], v[64:67], v[164:167], v[212:215]
    buffer_load_dwordx4 v[44:47], v4, s[56:59], s72 offen sc1
    v_mfma_f32_16x16x32_bf16 v[232:235], v[64:67], v[168:171], v[232:235]
    v_mfma_f32_16x16x32_bf16 v[252:255], v[64:67], v[172:175], v[252:255]
    s_waitcnt vmcnt(49)
    ds_read_b128 v[64:67], v3 offset:4096
    s_waitcnt vmcnt(16) lgkmcnt(4)
    v_mfma_f32_16x16x32_bf16 v[176:179], v[48:51], v[8:11], v[176:179]
    s_waitcnt vmcnt(15) lgkmcnt(4)
    v_mfma_f32_16x16x32_bf16 v[196:199], v[48:51], v[12:15], v[196:199]
    buffer_load_dwordx4 v[156:159], v5, s[56:59], s72 offen sc1
    s_waitcnt vmcnt(15) lgkmcnt(4)
    v_mfma_f32_16x16x32_bf16 v[216:219], v[48:51], v[16:19], v[216:219]
    s_waitcnt vmcnt(14) lgkmcnt(4)
    v_mfma_f32_16x16x32_bf16 v[236:239], v[48:51], v[20:23], v[236:239]
    s_waitcnt vmcnt(49)
    ds_read_b128 v[48:51], v3 offset:5120
    s_waitcnt lgkmcnt(4)
    v_mfma_f32_16x16x32_bf16 v[180:183], v[52:55], v[8:11], v[180:183]
    buffer_load_dwordx4 v[160:163], v6, s[56:59], s72 offen sc1
    v_mfma_f32_16x16x32_bf16 v[200:203], v[52:55], v[12:15], v[200:203]
    v_mfma_f32_16x16x32_bf16 v[220:223], v[52:55], v[16:19], v[220:223]
    v_mfma_f32_16x16x32_bf16 v[240:243], v[52:55], v[20:23], v[240:243]
    s_waitcnt vmcnt(49)
    ds_read_b128 v[52:55], v3 offset:6144
    s_waitcnt lgkmcnt(4)
    v_mfma_f32_16x16x32_bf16 v[184:187], v[56:59], v[8:11], v[184:187]
    buffer_load_dwordx4 v[164:167], v7, s[56:59], s72 offen sc1
    s_add_u32 s72, s72, 4096
    s_cmp_eq_u32 s72, s74
    s_cselect_b32 s72, s68, s72
    v_mfma_f32_16x16x32_bf16 v[204:207], v[56:59], v[12:15], v[204:207]
    v_mfma_f32_16x16x32_bf16 v[224:227], v[56:59], v[16:19], v[224:227]
    v_mfma_f32_16x16x32_bf16 v[244:247], v[56:59], v[20:23], v[244:247]
    s_waitcnt vmcnt(49)
    ds_read_b128 v[56:59], v3 offset:7168
    buffer_load_dwordx4 v[168:171], v4, s[56:59], s72 offen sc1
    s_waitcnt lgkmcnt(4)
    v_mfma_f32_16x16x32_bf16 v[188:191], v[60:63], v[8:11], v[188:191]
    v_mfma_f32_16x16x32_bf16 v[208:211], v[60:63], v[12:15], v[208:211]
    v_mfma_f32_16x16x32_bf16 v[228:231], v[60:63], v[16:19], v[228:231]
    v_mfma_f32_16x16x32_bf16 v[248:251], v[60:63], v[20:23], v[248:251]
    s_waitcnt vmcnt(49)
    ds_read_b128 v[60:63], v3 offset:8192
    buffer_load_dwordx4 v[172:175], v5, s[56:59], s72 offen sc1
    s_waitcnt lgkmcnt(4)
    v_mfma_f32_16x16x32_bf16 v[192:195], v[64:67], v[8:11], v[192:195]
    v_mfma_f32_16x16x32_bf16 v[212:215], v[64:67], v[12:15], v[212:215]
    v_mfma_f32_16x16x32_bf16 v[232:235], v[64:67], v[16:19], v[232:235]
    buffer_load_dwordx4 v[8:11], v6, s[56:59], s72 offen sc1
    v_mfma_f32_16x16x32_bf16 v[252:255], v[64:67], v[20:23], v[252:255]
    s_waitcnt vmcnt(50)
    ds_read_b128 v[64:67], v3 offset:9216
    s_waitcnt vmcnt(18) lgkmcnt(4)
    v_mfma_f32_16x16x32_bf16 v[176:179], v[48:51], v[128:131], v[176:179]
    s_waitcnt vmcnt(17) lgkmcnt(4)
    v_mfma_f32_16x16x32_bf16 v[196:199], v[48:51], v[132:135], v[196:199]
    s_waitcnt vmcnt(16) lgkmcnt(4)
    v_mfma_f32_16x16x32_bf16 v[216:219], v[48:51], v[136:139], v[216:219]
    buffer_load_dwordx4 v[12:15], v7, s[56:59], s72 offen sc1
    s_add_u32 s72, s72, 4096
    s_cmp_eq_u32 s72, s74
    s_cselect_b32 s72, s68, s72
    s_waitcnt vmcnt(16) lgkmcnt(4)
    v_mfma_f32_16x16x32_bf16 v[236:239], v[48:51], v[24:27], v[236:239]
    s_waitcnt vmcnt(50)
    ds_read_b128 v[48:51], v3 offset:10240
    s_waitcnt lgkmcnt(4)
    v_mfma_f32_16x16x32_bf16 v[180:183], v[52:55], v[128:131], v[180:183]
    v_mfma_f32_16x16x32_bf16 v[200:203], v[52:55], v[132:135], v[200:203]
    s_add_u32 s14, s5, 51200
    s_cmp_ge_u32 s14, 61440
    s_cselect_b32 s15, 61440, 0
    s_sub_u32 s14, s14, s15
    s_add_u32 s14, s14, s69
    buffer_load_dwordx4 v[16:19], v2, s[56:59], s14 offen offset:0 sc1
    v_mfma_f32_16x16x32_bf16 v[220:223], v[52:55], v[136:139], v[220:223]
    v_mfma_f32_16x16x32_bf16 v[240:243], v[52:55], v[24:27], v[240:243]
    s_waitcnt vmcnt(50)
    ds_read_b128 v[52:55], v3 offset:11264
    s_waitcnt lgkmcnt(4)
    v_mfma_f32_16x16x32_bf16 v[184:187], v[56:59], v[128:131], v[184:187]
    v_mfma_f32_16x16x32_bf16 v[204:207], v[56:59], v[132:135], v[204:207]
    buffer_load_dwordx4 v[20:23], v2, s[56:59], s14 offen offset:1024 sc1
    v_mfma_f32_16x16x32_bf16 v[224:227], v[56:59], v[136:139], v[224:227]
    v_mfma_f32_16x16x32_bf16 v[244:247], v[56:59], v[24:27], v[244:247]
    s_waitcnt vmcnt(50)
    ds_read_b128 v[56:59], v3 offset:12288
    s_waitcnt lgkmcnt(4)
    v_mfma_f32_16x16x32_bf16 v[188:191], v[60:63], v[128:131], v[188:191]
    v_mfma_f32_16x16x32_bf16 v[208:211], v[60:63], v[132:135], v[208:211]
    v_mfma_f32_16x16x32_bf16 v[228:231], v[60:63], v[136:139], v[228:231]
    v_mfma_f32_16x16x32_bf16 v[248:251], v[60:63], v[24:27], v[248:251]
    s_waitcnt vmcnt(49)
    ds_read_b128 v[60:63], v3 offset:13312
    s_waitcnt lgkmcnt(4)
    v_mfma_f32_16x16x32_bf16 v[192:195], v[64:67], v[128:131], v[192:195]
    buffer_load_dwordx4 v[128:131], v2, s[56:59], s14 offen offset:2048 sc1
    v_mfma_f32_16x16x32_bf16 v[212:215], v[64:67], v[132:135], v[212:215]
    buffer_load_dwordx4 v[132:135], v2, s[56:59], s14 offen offset:3072 sc1
    v_mfma_f32_16x16x32_bf16 v[232:235], v[64:67], v[136:139], v[232:235]
    v_mfma_f32_16x16x32_bf16 v[252:255], v[64:67], v[24:27], v[252:255]
    s_waitcnt vmcnt(50)
    ds_read_b128 v[64:67], v3 offset:14336
    s_waitcnt vmcnt(19) lgkmcnt(4)
    v_mfma_f32_16x16x32_bf16 v[176:179], v[48:51], v[140:143], v[176:179]
    s_add_u32 s14, s14, 4096
    buffer_load_dwordx4 v[136:139], v2, s[56:59], s14 offen offset:0 sc1
    s_waitcnt vmcnt(19) lgkmcnt(4)
    v_mfma_f32_16x16x32_bf16 v[196:199], v[48:51], v[28:31], v[196:199]
    s_waitcnt vmcnt(18) lgkmcnt(4)
    v_mfma_f32_16x16x32_bf16 v[216:219], v[48:51], v[32:35], v[216:219]
    s_waitcnt vmcnt(17) lgkmcnt(4)
    v_mfma_f32_16x16x32_bf16 v[236:239], v[48:51], v[36:39], v[236:239]
    s_waitcnt vmcnt(50)
    ds_read_b128 v[48:51], v0 offset:0
    buffer_load_dwordx4 v[24:27], v4, s[56:59], s72 offen sc1
    s_waitcnt lgkmcnt(4)
    v_mfma_f32_16x16x32_bf16 v[180:183], v[52:55], v[140:143], v[180:183]
    v_mfma_f32_16x16x32_bf16 v[200:203], v[52:55], v[28:31], v[200:203]
    v_mfma_f32_16x16x32_bf16 v[220:223], v[52:55], v[32:35], v[220:223]
    v_mfma_f32_16x16x32_bf16 v[240:243], v[52:55], v[36:39], v[240:243]
    s_waitcnt vmcnt(50)
    ds_read_b128 v[52:55], v0 offset:1024
    s_waitcnt lgkmcnt(4)
    v_mfma_f32_16x16x32_bf16 v[184:187], v[56:59], v[140:143], v[184:187]
    v_mfma_f32_16x16x32_bf16 v[204:207], v[56:59], v[28:31], v[204:207]
    v_mfma_f32_16x16x32_bf16 v[224:227], v[56:59], v[32:35], v[224:227]
    v_mfma_f32_16x16x32_bf16 v[244:247], v[56:59], v[36:39], v[244:247]
    s_waitcnt vmcnt(49)
    ds_read_b128 v[56:59], v0 offset:2048
    s_waitcnt lgkmcnt(4)
    v_mfma_f32_16x16x32_bf16 v[188:191], v[60:63], v[140:143], v[188:191]
    v_mfma_f32_16x16x32_bf16 v[208:211], v[60:63], v[28:31], v[208:211]
    v_mfma_f32_16x16x32_bf16 v[228:231], v[60:63], v[32:35], v[228:231]
    v_mfma_f32_16x16x32_bf16 v[248:251], v[60:63], v[36:39], v[248:251]
    s_waitcnt vmcnt(48)
    ds_read_b128 v[60:63], v0 offset:3072
    s_waitcnt lgkmcnt(4)
    v_mfma_f32_16x16x32_bf16 v[192:195], v[64:67], v[140:143], v[192:195]
    buffer_load_dwordx4 v[140:143], v5, s[56:59], s72 offen sc1
    v_mfma_f32_16x16x32_bf16 v[212:215], v[64:67], v[28:31], v[212:215]
    buffer_load_dwordx4 v[28:31], v6, s[56:59], s72 offen sc1
    v_mfma_f32_16x16x32_bf16 v[232:235], v[64:67], v[32:35], v[232:235]
    v_mfma_f32_16x16x32_bf16 v[252:255], v[64:67], v[36:39], v[252:255]
    s_waitcnt vmcnt(49)
    ds_read_b128 v[64:67], v0 offset:4096
    s_waitcnt vmcnt(19) lgkmcnt(4)
    v_mfma_f32_16x16x32_bf16 v[176:179], v[48:51], v[40:43], v[176:179]
    buffer_load_dwordx4 v[32:35], v7, s[56:59], s72 offen sc1
    s_add_u32 s72, s72, 4096
    s_cmp_eq_u32 s72, s74
    s_cselect_b32 s72, s68, s72
    s_waitcnt vmcnt(19) lgkmcnt(4)
    v_mfma_f32_16x16x32_bf16 v[196:199], v[48:51], v[144:147], v[196:199]
    s_waitcnt vmcnt(18) lgkmcnt(4)
    v_mfma_f32_16x16x32_bf16 v[216:219], v[48:51], v[148:151], v[216:219]
    s_waitcnt vmcnt(17) lgkmcnt(4)
    v_mfma_f32_16x16x32_bf16 v[236:239], v[48:51], v[152:155], v[236:239]
    s_add_u32 s14, s5, 56320
    s_cmp_ge_u32 s14, 61440
    s_cselect_b32 s15, 61440, 0
    s_sub_u32 s14, s14, s15
    s_add_u32 s14, s14, s69
    buffer_load_dwordx4 v[36:39], v2, s[56:59], s14 offen offset:0 sc1
    s_waitcnt lgkmcnt(3)
    v_mfma_f32_16x16x32_bf16 v[180:183], v[52:55], v[40:43], v[180:183]
    v_mfma_f32_16x16x32_bf16 v[200:203], v[52:55], v[144:147], v[200:203]
    v_mfma_f32_16x16x32_bf16 v[220:223], v[52:55], v[148:151], v[220:223]
    v_mfma_f32_16x16x32_bf16 v[240:243], v[52:55], v[152:155], v[240:243]
    buffer_load_dwordx4 v[48:51], v2, s[56:59], s14 offen offset:1024 sc1
    s_waitcnt lgkmcnt(2)
    v_mfma_f32_16x16x32_bf16 v[184:187], v[56:59], v[40:43], v[184:187]
    v_mfma_f32_16x16x32_bf16 v[204:207], v[56:59], v[144:147], v[204:207]
    v_mfma_f32_16x16x32_bf16 v[224:227], v[56:59], v[148:151], v[224:227]
    buffer_load_dwordx4 v[52:55], v2, s[56:59], s14 offen offset:2048 sc1
    v_mfma_f32_16x16x32_bf16 v[244:247], v[56:59], v[152:155], v[244:247]
    s_waitcnt lgkmcnt(1)
    v_mfma_f32_16x16x32_bf16 v[188:191], v[60:63], v[40:43], v[188:191]
    v_mfma_f32_16x16x32_bf16 v[208:211], v[60:63], v[144:147], v[208:211]
    v_mfma_f32_16x16x32_bf16 v[228:231], v[60:63], v[148:151], v[228:231]
    buffer_load_dwordx4 v[56:59], v2, s[56:59], s14 offen offset:3072 sc1
    v_mfma_f32_16x16x32_bf16 v[248:251], v[60:63], v[152:155], v[248:251]
    s_waitcnt lgkmcnt(0)
    v_mfma_f32_16x16x32_bf16 v[192:195], v[64:67], v[40:43], v[192:195]
    v_mfma_f32_16x16x32_bf16 v[212:215], v[64:67], v[144:147], v[212:215]
    s_add_u32 s14, s14, 4096
    buffer_load_dwordx4 v[60:63], v2, s[56:59], s14 offen offset:0 sc1
    v_mfma_f32_16x16x32_bf16 v[232:235], v[64:67], v[148:151], v[232:235]
    v_mfma_f32_16x16x32_bf16 v[252:255], v[64:67], v[152:155], v[252:255]
    s_waitcnt vmcnt(21)
    v_mfma_f32_16x16x32_bf16 v[176:179], v[68:71], v[44:47], v[176:179]
    s_waitcnt vmcnt(20)
    v_mfma_f32_16x16x32_bf16 v[196:199], v[68:71], v[156:159], v[196:199]
    buffer_load_dwordx4 v[40:43], v4, s[56:59], s72 offen sc1
    s_waitcnt vmcnt(20)
    v_mfma_f32_16x16x32_bf16 v[216:219], v[68:71], v[160:163], v[216:219]
    s_waitcnt vmcnt(19)
    v_mfma_f32_16x16x32_bf16 v[236:239], v[68:71], v[164:167], v[236:239]
    s_waitcnt vmcnt(63)
    v_mfma_f32_16x16x32_bf16 v[180:183], v[72:75], v[44:47], v[180:183]
    buffer_load_dwordx4 v[144:147], v5, s[56:59], s72 offen sc1
    v_mfma_f32_16x16x32_bf16 v[200:203], v[72:75], v[156:159], v[200:203]
    v_mfma_f32_16x16x32_bf16 v[220:223], v[72:75], v[160:163], v[220:223]
    v_mfma_f32_16x16x32_bf16 v[240:243], v[72:75], v[164:167], v[240:243]
    s_waitcnt vmcnt(63)
    v_mfma_f32_16x16x32_bf16 v[184:187], v[76:79], v[44:47], v[184:187]
    buffer_load_dwordx4 v[148:151], v6, s[56:59], s72 offen sc1
    v_mfma_f32_16x16x32_bf16 v[204:207], v[76:79], v[156:159], v[204:207]
    v_mfma_f32_16x16x32_bf16 v[224:227], v[76:79], v[160:163], v[224:227]
    v_mfma_f32_16x16x32_bf16 v[244:247], v[76:79], v[164:167], v[244:247]
    buffer_load_dwordx4 v[64:67], v7, s[56:59], s72 offen sc1
    s_add_u32 s72, s72, 4096
    s_cmp_eq_u32 s72, s74
    s_cselect_b32 s72, s68, s72
    s_waitcnt vmcnt(63)
    v_mfma_f32_16x16x32_bf16 v[188:191], v[80:83], v[44:47], v[188:191]
    v_mfma_f32_16x16x32_bf16 v[208:211], v[80:83], v[156:159], v[208:211]
    v_mfma_f32_16x16x32_bf16 v[228:231], v[80:83], v[160:163], v[228:231]
    v_mfma_f32_16x16x32_bf16 v[248:251], v[80:83], v[164:167], v[248:251]
    buffer_load_dwordx4 v[152:155], v4, s[56:59], s72 offen sc1
    s_waitcnt vmcnt(63)
    v_mfma_f32_16x16x32_bf16 v[192:195], v[84:87], v[44:47], v[192:195]
    v_mfma_f32_16x16x32_bf16 v[212:215], v[84:87], v[156:159], v[212:215]
    v_mfma_f32_16x16x32_bf16 v[232:235], v[84:87], v[160:163], v[232:235]
    buffer_load_dwordx4 v[68:71], v5, s[56:59], s72 offen sc1
    v_mfma_f32_16x16x32_bf16 v[252:255], v[84:87], v[164:167], v[252:255]
    s_waitcnt vmcnt(23)
    v_mfma_f32_16x16x32_bf16 v[176:179], v[88:91], v[168:171], v[176:179]
    s_waitcnt vmcnt(22)
    v_mfma_f32_16x16x32_bf16 v[196:199], v[88:91], v[172:175], v[196:199]
    s_waitcnt vmcnt(21)
    v_mfma_f32_16x16x32_bf16 v[216:219], v[88:91], v[8:11], v[216:219]
    buffer_load_dwordx4 v[72:75], v6, s[56:59], s72 offen sc1
    s_waitcnt vmcnt(21)
    v_mfma_f32_16x16x32_bf16 v[236:239], v[88:91], v[12:15], v[236:239]
    s_waitcnt vmcnt(63)
    v_mfma_f32_16x16x32_bf16 v[180:183], v[92:95], v[168:171], v[180:183]
    v_mfma_f32_16x16x32_bf16 v[200:203], v[92:95], v[172:175], v[200:203]
    buffer_load_dwordx4 v[76:79], v7, s[56:59], s72 offen sc1
    s_add_u32 s72, s72, 4096
    s_cmp_eq_u32 s72, s74
    s_cselect_b32 s72, s68, s72
    v_mfma_f32_16x16x32_bf16 v[220:223], v[92:95], v[8:11], v[220:223]
    v_mfma_f32_16x16x32_bf16 v[240:243], v[92:95], v[12:15], v[240:243]
    s_waitcnt vmcnt(63)
    v_mfma_f32_16x16x32_bf16 v[184:187], v[96:99], v[168:171], v[184:187]
    v_mfma_f32_16x16x32_bf16 v[204:207], v[96:99], v[172:175], v[204:207]
    s_mul_i32 s6, s11, 2688
    s_mul_i32 s12, s8, 320
    s_add_u32 s12, s12, s6
    s_add_u32 s12, s12, 262144
    v_min_u32 v80, 39, v1
    v_lshlrev_b32 v80, 3, v80
    s_lshl_b32 s13, s11, 2
    s_add_u32 s13, s13, s3
    s_lshl_b32 s13, s13, 7
    s_add_u32 s77, s13, 131072
    v_and_b32 v81, 15, v1
    v_lshlrev_b32 v81, 3, v81
    buffer_load_dwordx2 v[44:45], v81, s[56:59], s77 offen sc1
    buffer_load_dwordx2 v[82:83], v80, s[56:59], s12 offen sc1
    s_mul_i32 s13, s8, 80
    s_lshl_b32 s6, s3, 4
    s_add_u32 s13, s13, s6
    s_lshl_b32 s13, s13, 12
    s_lshl_b32 s6, s11, 7
    s_add_u32 s13, s13, s6
    s_add_u32 s73, s13, 6291456
    v_lshrrev_b32 v46, 3, v1
    v_lshlrev_b32 v46, 12, v46
    v_and_b32 v47, 7, v1
    v_lshl_add_u32 v46, v47, 4, v46
    s_mul_i32 s75, s3, 5120
    s_add_u32 s75, s75, 61440
    v_mfma_f32_16x16x32_bf16 v[224:227], v[96:99], v[8:11], v[224:227]
    v_mfma_f32_16x16x32_bf16 v[244:247], v[96:99], v[12:15], v[244:247]
    s_waitcnt vmcnt(63)
    v_mfma_f32_16x16x32_bf16 v[188:191], v[100:103], v[168:171], v[188:191]
    v_mfma_f32_16x16x32_bf16 v[208:211], v[100:103], v[172:175], v[208:211]
    v_mfma_f32_16x16x32_bf16 v[228:231], v[100:103], v[8:11], v[228:231]
    v_mfma_f32_16x16x32_bf16 v[248:251], v[100:103], v[12:15], v[248:251]
    s_waitcnt vmcnt(63)
    v_mfma_f32_16x16x32_bf16 v[192:195], v[104:107], v[168:171], v[192:195]
    v_mfma_f32_16x16x32_bf16 v[212:215], v[104:107], v[172:175], v[212:215]
    v_mfma_f32_16x16x32_bf16 v[232:235], v[104:107], v[8:11], v[232:235]
    v_mfma_f32_16x16x32_bf16 v[252:255], v[104:107], v[12:15], v[252:255]
    s_waitcnt vmcnt(18)
    v_mfma_f32_16x16x32_bf16 v[176:179], v[108:111], v[24:27], v[176:179]
    s_waitcnt vmcnt(17)
    v_mfma_f32_16x16x32_bf16 v[196:199], v[108:111], v[140:143], v[196:199]
    s_waitcnt vmcnt(16)
    v_mfma_f32_16x16x32_bf16 v[216:219], v[108:111], v[28:31], v[216:219]
    s_waitcnt vmcnt(15)
    v_mfma_f32_16x16x32_bf16 v[236:239], v[108:111], v[32:35], v[236:239]
    s_waitcnt vmcnt(63)
    v_mfma_f32_16x16x32_bf16 v[180:183], v[112:115], v[24:27], v[180:183]
    v_mfma_f32_16x16x32_bf16 v[200:203], v[112:115], v[140:143], v[200:203]
    v_mfma_f32_16x16x32_bf16 v[220:223], v[112:115], v[28:31], v[220:223]
    v_mfma_f32_16x16x32_bf16 v[240:243], v[112:115], v[32:35], v[240:243]
    s_waitcnt vmcnt(62)
    v_mfma_f32_16x16x32_bf16 v[184:187], v[116:119], v[24:27], v[184:187]
    v_mfma_f32_16x16x32_bf16 v[204:207], v[116:119], v[140:143], v[204:207]
    v_mfma_f32_16x16x32_bf16 v[224:227], v[116:119], v[28:31], v[224:227]
    v_mfma_f32_16x16x32_bf16 v[244:247], v[116:119], v[32:35], v[244:247]
    s_waitcnt vmcnt(61)
    v_mfma_f32_16x16x32_bf16 v[188:191], v[120:123], v[24:27], v[188:191]
    v_mfma_f32_16x16x32_bf16 v[208:211], v[120:123], v[140:143], v[208:211]
    v_mfma_f32_16x16x32_bf16 v[228:231], v[120:123], v[28:31], v[228:231]
    v_mfma_f32_16x16x32_bf16 v[248:251], v[120:123], v[32:35], v[248:251]
    s_waitcnt vmcnt(60)
    v_mfma_f32_16x16x32_bf16 v[192:195], v[124:127], v[24:27], v[192:195]
    v_mfma_f32_16x16x32_bf16 v[212:215], v[124:127], v[140:143], v[212:215]
    v_mfma_f32_16x16x32_bf16 v[232:235], v[124:127], v[28:31], v[232:235]
    v_mfma_f32_16x16x32_bf16 v[252:255], v[124:127], v[32:35], v[252:255]
    s_waitcnt vmcnt(0) lgkmcnt(0)
    s_mov_b32 s76, 0
    v_xor_b32 v82, s4, v82
    v_xor_b32 v83, s4, v83
    v_or_b32 v82, v82, v83
    v_cmp_ne_u32 vcc, 0, v82
    s_cbranch_vccnz Lnoat_7
    s_mov_b32 m0, s75
    s_add_u32 s13, s73, 31744
    buffer_load_dwordx4 v46, s[56:59], s73 offen sc1 nt lds
    buffer_load_dwordx4 v46, s[56:59], s13 offen offset:1024 sc1 nt lds
    s_mul_i32 s6, s3, 49152
    s_sub_u32 s13, s73, s6
    s_add_u32 s13, s13, 260096
    s_mov_b32 exec_hi, 0
    buffer_load_dwordx4 v46, s[56:59], s13 offen offset:2048 sc1 nt lds
    s_mov_b64 exec, -1
    s_mov_b32 s76, 1
    s_branch Latj_8
Lnoat_7:
    s_waitcnt vmcnt(0)
Latj_8:
    v_mfma_f32_16x16x32_bf16 v[176:179], v[16:19], v[40:43], v[176:179]
    v_mfma_f32_16x16x32_bf16 v[180:183], v[20:23], v[40:43], v[180:183]
    v_mfma_f32_16x16x32_bf16 v[184:187], v[128:131], v[40:43], v[184:187]
    v_mfma_f32_16x16x32_bf16 v[188:191], v[132:135], v[40:43], v[188:191]
    v_mfma_f32_16x16x32_bf16 v[192:195], v[136:139], v[40:43], v[192:195]
    v_mfma_f32_16x16x32_bf16 v[176:179], v[36:39], v[152:155], v[176:179]
    v_mfma_f32_16x16x32_bf16 v[180:183], v[48:51], v[152:155], v[180:183]
    v_mfma_f32_16x16x32_bf16 v[184:187], v[52:55], v[152:155], v[184:187]
    v_mfma_f32_16x16x32_bf16 v[188:191], v[56:59], v[152:155], v[188:191]
    v_mfma_f32_16x16x32_bf16 v[192:195], v[60:63], v[152:155], v[192:195]
    v_mfma_f32_16x16x32_bf16 v[196:199], v[16:19], v[144:147], v[196:199]
    v_mfma_f32_16x16x32_bf16 v[200:203], v[20:23], v[144:147], v[200:203]
    s_nop 1
    ds_write_b128 v3, v[176:179] offset:0
    v_mfma_f32_16x16x32_bf16 v[204:207], v[128:131], v[144:147], v[204:207]
    v_mfma_f32_16x16x32_bf16 v[208:211], v[132:135], v[144:147], v[208:211]
    ds_write_b128 v3, v[180:183] offset:1024
    v_mfma_f32_16x16x32_bf16 v[212:215], v[136:139], v[144:147], v[212:215]
    v_mfma_f32_16x16x32_bf16 v[196:199], v[36:39], v[68:71], v[196:199]
    ds_write_b128 v3, v[184:187] offset:2048
    v_mfma_f32_16x16x32_bf16 v[200:203], v[48:51], v[68:71], v[200:203]
    v_mfma_f32_16x16x32_bf16 v[204:207], v[52:55], v[68:71], v[204:207]
    ds_write_b128 v3, v[188:191] offset:3072
    v_mfma_f32_16x16x32_bf16 v[208:211], v[56:59], v[68:71], v[208:211]
    v_mfma_f32_16x16x32_bf16 v[212:215], v[60:63], v[68:71], v[212:215]
    ds_write_b128 v3, v[192:195] offset:4096
    v_mfma_f32_16x16x32_bf16 v[216:219], v[16:19], v[148:151], v[216:219]
    v_mfma_f32_16x16x32_bf16 v[220:223], v[20:23], v[148:151], v[220:223]
    ds_write_b128 v3, v[196:199] offset:5120
    v_mfma_f32_16x16x32_bf16 v[224:227], v[128:131], v[148:151], v[224:227]
    v_mfma_f32_16x16x32_bf16 v[228:231], v[132:135], v[148:151], v[228:231]
    ds_write_b128 v3, v[200:203] offset:6144
    v_mfma_f32_16x16x32_bf16 v[232:235], v[136:139], v[148:151], v[232:235]
    v_mfma_f32_16x16x32_bf16 v[216:219], v[36:39], v[72:75], v[216:219]
    ds_write_b128 v3, v[204:207] offset:7168
    v_mfma_f32_16x16x32_bf16 v[220:223], v[48:51], v[72:75], v[220:223]
    v_mfma_f32_16x16x32_bf16 v[224:227], v[52:55], v[72:75], v[224:227]
    ds_write_b128 v3, v[208:211] offset:8192
    v_mfma_f32_16x16x32_bf16 v[228:231], v[56:59], v[72:75], v[228:231]
    v_mfma_f32_16x16x32_bf16 v[232:235], v[60:63], v[72:75], v[232:235]
    ds_write_b128 v3, v[212:215] offset:9216
    v_mfma_f32_16x16x32_bf16 v[236:239], v[16:19], v[64:67], v[236:239]
    v_mfma_f32_16x16x32_bf16 v[240:243], v[20:23], v[64:67], v[240:243]
    ds_write_b128 v3, v[216:219] offset:10240
    v_mfma_f32_16x16x32_bf16 v[244:247], v[128:131], v[64:67], v[244:247]
    v_mfma_f32_16x16x32_bf16 v[248:251], v[132:135], v[64:67], v[248:251]
    ds_write_b128 v3, v[220:223] offset:11264
    v_mfma_f32_16x16x32_bf16 v[252:255], v[136:139], v[64:67], v[252:255]
    v_mfma_f32_16x16x32_bf16 v[236:239], v[36:39], v[76:79], v[236:239]
    ds_write_b128 v3, v[224:227] offset:12288
    v_mfma_f32_16x16x32_bf16 v[240:243], v[48:51], v[76:79], v[240:243]
    v_mfma_f32_16x16x32_bf16 v[244:247], v[52:55], v[76:79], v[244:247]
    ds_write_b128 v3, v[228:231] offset:13312
    v_mfma_f32_16x16x32_bf16 v[248:251], v[56:59], v[76:79], v[248:251]
    v_mfma_f32_16x16x32_bf16 v[252:255], v[60:63], v[76:79], v[252:255]
    ds_write_b128 v3, v[232:235] offset:14336
    s_cmp_eq_u32 s76, 1
    s_cbranch_scc1 Lhasat_9
    s_mov_b32 s15, 20000
Lpoll_10:
    buffer_load_dwordx2 v[82:83], v80, s[56:59], s12 offen sc1
    s_waitcnt vmcnt(0)
    v_xor_b32 v82, s4, v82
    v_xor_b32 v83, s4, v83
    v_or_b32 v82, v82, v83
    v_cmp_ne_u32 vcc, 0, v82
    s_cbranch_vccz Lpdone_11
    s_sub_u32 s15, s15, 1
    s_cbranch_scc0 Lpoll_10
Lpdone_11:
    s_mov_b32 m0, s75
    s_add_u32 s13, s73, 31744
    buffer_load_dwordx4 v46, s[56:59], s73 offen sc1 nt lds
    buffer_load_dwordx4 v46, s[56:59], s13 offen offset:1024 sc1 nt lds
    s_mul_i32 s6, s3, 49152
    s_sub_u32 s13, s73, s6
    s_add_u32 s13, s13, 260096
    s_mov_b32 exec_hi, 0
    buffer_load_dwordx4 v46, s[56:59], s13 offen offset:2048 sc1 nt lds
    s_mov_b64 exec, -1
Lhasat_9:
    s_mov_b32 s15, 20000
Lgp_12:
    v_cmp_ne_u32 vcc, s4, v45
    s_cbranch_vccz Lgd_13
    buffer_load_dwordx2 v[44:45], v81, s[56:59], s77 offen sc1
    s_waitcnt vmcnt(0)
    s_sub_u32 s15, s15, 1
    s_cbranch_scc0 Lgp_12
Lgd_13:
    s_sub_u32 s6, s3, 1
    s_and_b32 s6, s6, 3
    s_mul_i32 s6, s6, 15360
    s_add_u32 s6, s6, 0
    v_add_u32 v4, s6, v2
    s_sub_u32 s6, s3, 2
    s_and_b32 s6, s6, 3
    s_mul_i32 s6, s6, 15360
    s_add_u32 s6, s6, 5120
    v_add_u32 v5, s6, v2
    s_sub_u32 s6, s3, 3
    s_and_b32 s6, s6, 3
    s_mul_i32 s6, s6, 15360
    s_add_u32 s6, s6, 10240
    v_add_u32 v6, s6, v2
    v_lshrrev_b32 v7, 2, v1
    v_lshlrev_b32 v7, 7, v7
    v_and_b32 v0, 3, v1
    v_lshl_add_u32 v7, v0, 3, v7
    s_lshl_b32 s13, s3, 5
    s_add_u32 s13, s13, 61440
    v_add_u32 v7, s13, v7
    v_lshrrev_b32 v0, 4, v1
    v_mul_u32_u24 v0, 4608, v0
    v_add_u32 v0, v0, v7
    s_waitcnt vmcnt(0) lgkmcnt(0)
    s_barrier
    ds_read_b64_tr_b16 v[8:9], v7 offset:0
    ds_read_b64_tr_b16 v[10:11], v7 offset:5120
    ds_read_b64_tr_b16 v[12:13], v7 offset:10240
    ds_read_b64_tr_b16 v[14:15], v7 offset:15360
    ds_read_b64_tr_b16 v[16:17], v0 offset:2048
    ds_read_b128 v[20:23], v4 offset:0
    ds_read_b128 v[24:27], v4 offset:1024
    ds_read_b128 v[28:31], v4 offset:2048
    ds_read_b128 v[32:35], v4 offset:3072
    ds_read_b128 v[36:39], v4 offset:4096
    ds_read_b128 v[40:43], v5 offset:0
    ds_read_b128 v[48:51], v5 offset:1024
    ds_read_b128 v[52:55], v5 offset:2048
    ds_read_b128 v[56:59], v5 offset:3072
    ds_read_b128 v[60:63], v5 offset:4096
    v_mov_b32 v45, v44
    v_sub_f32 v46, 1.0, v44
    s_mov_b32 s13, 0xffff0000
    v_cvt_pk_bf16_f32 v46, 0, v46
    s_waitcnt lgkmcnt(10)
    ds_read_b128 v[64:67], v6 offset:0
    ds_read_b128 v[68:71], v6 offset:1024
    ds_read_b128 v[72:75], v6 offset:2048
    ds_read_b128 v[76:79], v6 offset:3072
    ds_read_b128 v[80:83], v6 offset:4096
    v_mov_b32 v47, v46
    v_lshlrev_b32 v84, 16, v8
    v_and_b32 v85, s13, v8
    v_lshlrev_b32 v86, 16, v9
    v_and_b32 v87, s13, v9
    v_pk_mul_f32 v[84:85], v[84:85], v[44:45]
    v_pk_mul_f32 v[86:87], v[86:87], v[44:45]
    v_cvt_pk_bf16_f32 v84, 0, v84
    v_cvt_pk_bf16_f32 v85, 0, v85
    v_cvt_pk_bf16_f32 v86, 0, v86
    v_cvt_pk_bf16_f32 v87, 0, v87
    v_lshlrev_b32 v88, 16, v10
    v_and_b32 v89, s13, v10
    v_lshlrev_b32 v90, 16, v11
    v_and_b32 v91, s13, v11
    v_pk_mul_f32 v[88:89], v[88:89], v[44:45]
    v_pk_mul_f32 v[90:91], v[90:91], v[44:45]
    v_cvt_pk_bf16_f32 v88, 0, v88
    v_cvt_pk_bf16_f32 v89, 0, v89
    v_cvt_pk_bf16_f32 v90, 0, v90
    v_cvt_pk_bf16_f32 v91, 0, v91
    v_lshlrev_b32 v92, 16, v12
    v_and_b32 v93, s13, v12
    v_lshlrev_b32 v94, 16, v13
    v_and_b32 v95, s13, v13
    v_pk_mul_f32 v[92:93], v[92:93], v[44:45]
    v_pk_mul_f32 v[94:95], v[94:95], v[44:45]
    v_cvt_pk_bf16_f32 v92, 0, v92
    v_cvt_pk_bf16_f32 v93, 0, v93
    v_cvt_pk_bf16_f32 v94, 0, v94
    v_cvt_pk_bf16_f32 v95, 0, v95
    v_lshlrev_b32 v96, 16, v14
    v_and_b32 v97, s13, v14
    v_lshlrev_b32 v98, 16, v15
    v_and_b32 v99, s13, v15
    v_pk_mul_f32 v[96:97], v[96:97], v[44:45]
    v_pk_mul_f32 v[98:99], v[98:99], v[44:45]
    v_cvt_pk_bf16_f32 v96, 0, v96
    v_cvt_pk_bf16_f32 v97, 0, v97
    v_cvt_pk_bf16_f32 v98, 0, v98
    v_cvt_pk_bf16_f32 v99, 0, v99
    v_lshlrev_b32 v100, 16, v16
    v_and_b32 v101, s13, v16
    v_lshlrev_b32 v102, 16, v17
    v_and_b32 v103, s13, v17
    v_pk_mul_f32 v[100:101], v[100:101], v[44:45]
    v_pk_mul_f32 v[102:103], v[102:103], v[44:45]
    v_cvt_pk_bf16_f32 v100, 0, v100
    v_cvt_pk_bf16_f32 v101, 0, v101
    v_cvt_pk_bf16_f32 v102, 0, v102
    v_cvt_pk_bf16_f32 v103, 0, v103
    s_waitcnt lgkmcnt(10)
    v_pk_add_f32 v[236:237], v[236:237], v[20:21]
    v_pk_add_f32 v[238:239], v[238:239], v[22:23]
    v_pk_add_f32 v[240:241], v[240:241], v[24:25]
    v_pk_add_f32 v[242:243], v[242:243], v[26:27]
    v_pk_add_f32 v[244:245], v[244:245], v[28:29]
    v_pk_add_f32 v[246:247], v[246:247], v[30:31]
    v_pk_add_f32 v[248:249], v[248:249], v[32:33]
    v_pk_add_f32 v[250:251], v[250:251], v[34:35]
    v_pk_add_f32 v[252:253], v[252:253], v[36:37]
    v_pk_add_f32 v[254:255], v[254:255], v[38:39]
    s_waitcnt lgkmcnt(5)
    v_pk_add_f32 v[236:237], v[236:237], v[40:41]
    v_pk_add_f32 v[238:239], v[238:239], v[42:43]
    v_pk_add_f32 v[240:241], v[240:241], v[48:49]
    v_pk_add_f32 v[242:243], v[242:243], v[50:51]
    v_pk_add_f32 v[244:245], v[244:245], v[52:53]
    v_pk_add_f32 v[246:247], v[246:247], v[54:55]
    v_pk_add_f32 v[248:249], v[248:249], v[56:57]
    v_pk_add_f32 v[250:251], v[250:251], v[58:59]
    v_pk_add_f32 v[252:253], v[252:253], v[60:61]
    v_pk_add_f32 v[254:255], v[254:255], v[62:63]
    s_waitcnt lgkmcnt(0)
    v_pk_add_f32 v[236:237], v[236:237], v[64:65]
    v_pk_add_f32 v[238:239], v[238:239], v[66:67]
    v_pk_add_f32 v[240:241], v[240:241], v[68:69]
    v_pk_add_f32 v[242:243], v[242:243], v[70:71]
    v_pk_add_f32 v[244:245], v[244:245], v[72:73]
    v_pk_add_f32 v[246:247], v[246:247], v[74:75]
    v_pk_add_f32 v[248:249], v[248:249], v[76:77]
    v_pk_add_f32 v[250:251], v[250:251], v[78:79]
    v_pk_add_f32 v[252:253], v[252:253], v[80:81]
    v_pk_add_f32 v[254:255], v[254:255], v[82:83]
    s_lshl_b32 s13, s11, 2
    s_add_u32 s13, s13, s3
    s_mul_i32 s13, s13, 20480
    s_mul_i32 s14, s8, 160
    s_add_u32 s13, s13, s14
    v_and_b32 v3, 15, v1
    v_mul_u32_u24 v3, 1280, v3
    v_lshrrev_b32 v5, 4, v1
    v_lshl_add_u32 v4, v5, 3, v3
    v_bfe_u32 v5, v1, 4, 1
    v_lshl_add_u32 v3, v5, 5, v3
    v_lshrrev_b32 v5, 5, v1
    v_lshl_add_u32 v3, v5, 4, v3
    v_cvt_pk_bf16_f32 v236, 0, v236
    v_cvt_pk_bf16_f32 v237, 0, v237
    v_cvt_pk_bf16_f32 v238, 0, v238
    v_cvt_pk_bf16_f32 v239, 0, v239
    v_pk_mul_f32 v[236:237], v[236:237], v[46:47]
    v_pk_mul_f32 v[238:239], v[238:239], v[46:47]
    v_cvt_pk_bf16_f32 v236, 0, v236
    v_cvt_pk_bf16_f32 v237, 0, v237
    v_cvt_pk_bf16_f32 v238, 0, v238
    v_cvt_pk_bf16_f32 v239, 0, v239
    v_pk_add_f32 v[236:237], v[236:237], v[84:85]
    v_pk_add_f32 v[238:239], v[238:239], v[86:87]
    v_cvt_pk_bf16_f32 v176, v236, v237
    v_cvt_pk_bf16_f32 v177, v238, v239
    v_cvt_pk_bf16_f32 v240, 0, v240
    v_cvt_pk_bf16_f32 v241, 0, v241
    v_cvt_pk_bf16_f32 v242, 0, v242
    v_cvt_pk_bf16_f32 v243, 0, v243
    v_pk_mul_f32 v[240:241], v[240:241], v[46:47]
    v_pk_mul_f32 v[242:243], v[242:243], v[46:47]
    v_cvt_pk_bf16_f32 v240, 0, v240
    v_cvt_pk_bf16_f32 v241, 0, v241
    v_cvt_pk_bf16_f32 v242, 0, v242
    v_cvt_pk_bf16_f32 v243, 0, v243
    v_pk_add_f32 v[240:241], v[240:241], v[88:89]
    v_pk_add_f32 v[242:243], v[242:243], v[90:91]
    v_cvt_pk_bf16_f32 v178, v240, v241
    v_cvt_pk_bf16_f32 v179, v242, v243
    s_nop 0
    v_permlane16_swap_b32 v176, v178
    v_permlane16_swap_b32 v177, v179
    buffer_store_dwordx4 v[176:179], v3, s[60:63], s13 offen offset:0
    v_cvt_pk_bf16_f32 v244, 0, v244
    v_cvt_pk_bf16_f32 v245, 0, v245
    v_cvt_pk_bf16_f32 v246, 0, v246
    v_cvt_pk_bf16_f32 v247, 0, v247
    v_pk_mul_f32 v[244:245], v[244:245], v[46:47]
    v_pk_mul_f32 v[246:247], v[246:247], v[46:47]
    v_cvt_pk_bf16_f32 v244, 0, v244
    v_cvt_pk_bf16_f32 v245, 0, v245
    v_cvt_pk_bf16_f32 v246, 0, v246
    v_cvt_pk_bf16_f32 v247, 0, v247
    v_pk_add_f32 v[244:245], v[244:245], v[92:93]
    v_pk_add_f32 v[246:247], v[246:247], v[94:95]
    v_cvt_pk_bf16_f32 v180, v244, v245
    v_cvt_pk_bf16_f32 v181, v246, v247
    v_cvt_pk_bf16_f32 v248, 0, v248
    v_cvt_pk_bf16_f32 v249, 0, v249
    v_cvt_pk_bf16_f32 v250, 0, v250
    v_cvt_pk_bf16_f32 v251, 0, v251
    v_pk_mul_f32 v[248:249], v[248:249], v[46:47]
    v_pk_mul_f32 v[250:251], v[250:251], v[46:47]
    v_cvt_pk_bf16_f32 v248, 0, v248
    v_cvt_pk_bf16_f32 v249, 0, v249
    v_cvt_pk_bf16_f32 v250, 0, v250
    v_cvt_pk_bf16_f32 v251, 0, v251
    v_pk_add_f32 v[248:249], v[248:249], v[96:97]
    v_pk_add_f32 v[250:251], v[250:251], v[98:99]
    v_cvt_pk_bf16_f32 v182, v248, v249
    v_cvt_pk_bf16_f32 v183, v250, v251
    s_nop 0
    v_permlane16_swap_b32 v180, v182
    v_permlane16_swap_b32 v181, v183
    buffer_store_dwordx4 v[180:183], v3, s[60:63], s13 offen offset:64
    v_cvt_pk_bf16_f32 v252, 0, v252
    v_cvt_pk_bf16_f32 v253, 0, v253
    v_cvt_pk_bf16_f32 v254, 0, v254
    v_cvt_pk_bf16_f32 v255, 0, v255
    v_pk_mul_f32 v[252:253], v[252:253], v[46:47]
    v_pk_mul_f32 v[254:255], v[254:255], v[46:47]
    v_cvt_pk_bf16_f32 v252, 0, v252
    v_cvt_pk_bf16_f32 v253, 0, v253
    v_cvt_pk_bf16_f32 v254, 0, v254
    v_cvt_pk_bf16_f32 v255, 0, v255
    v_pk_add_f32 v[252:253], v[252:253], v[100:101]
    v_pk_add_f32 v[254:255], v[254:255], v[102:103]
    v_cvt_pk_bf16_f32 v184, v252, v253
    v_cvt_pk_bf16_f32 v185, v254, v255
    buffer_store_dwordx2 v[184:185], v4, s[60:63], s13 offen offset:128
    s_endpgm
LC:
    s_and_b32 s5, s2, 255
    s_lshr_b32 s68, s5, 5
    s_and_b32 s69, s5, 31
    s_mul_i32 s6, s69, 3
    s_lshl_b32 s7, s69, 1
    s_add_u32 s7, s7, 16
    s_cmp_lt_u32 s69, 16
    s_cselect_b32 s6, s6, s7
    s_cselect_b32 s7, 3, 2
    s_mul_i32 s8, s68, 80
    s_add_u32 s6, s6, s8
    s_cmp_eq_u32 s3, 3
    s_cbranch_scc1 LW3
    s_cmp_ge_u32 s3, s7
    s_cbranch_scc1 LAUX
    s_add_u32 s6, s6, s3
    s_mul_i32 s8, s3, 12768
    s_mul_i32 s9, s6, 384
    v_mul_u32_u24 v2, 3, v1
    v_and_b32 v2, 0xfe, v2
    v_lshl_add_u32 v2, v2, 1, s9
    s_lshl_b32 s10, s6, 1
    s_and_b32 s10, s10, 0xfffc
    s_mov_b32 m0, s8
    v_and_b32 v6, 15, v1
    v_mul_u32_u24 v6, 800, v6
    v_lshrrev_b32 v7, 4, v1
    v_lshl_add_u32 v6, v7, 4, v6
    v_add_u32 v5, s8, v6
    v_and_b32 v3, 1, v1
    v_lshlrev_b32 v3, 4, v3
    v_sub_u32 v4, 16, v3
    s_mov_b32 s12, 0xffff0000
    s_waitcnt lgkmcnt(0)
    global_load_dwordx2 v[40:41], v2, s[18:19] nt
    global_load_dwordx2 v[42:43], v2, s[20:21] nt
    global_load_dwordx2 v[44:45], v2, s[22:23] nt
    global_load_dwordx2 v[46:47], v2, s[24:25] nt
    global_load_dwordx2 v[48:49], v2, s[26:27] nt
    global_load_dwordx2 v[50:51], v2, s[28:29] nt
    s_load_dword s70, s[30:31], s10
    s_load_dword s71, s[32:33], s10
    s_mov_b32 s56, s46
    s_mov_b32 s57, s47
    s_mov_b32 s58, 16777216
    s_mov_b32 s59, 0x20000
    s_mov_b32 s96, s46
    s_mov_b32 s97, s47
    s_load_dword s4, s[46:47], 0
    v_mov_b32 v6, 0x3f80
    ds_write_addtid_b32 v6 offset:0
    ds_write_addtid_b32 v6 offset:256
    ds_write_addtid_b32 v6 offset:512
    s_waitcnt lgkmcnt(0)
    s_add_u32 s4, s4, 1
    s_and_b32 s10, s6, 1
    s_lshl_b32 s10, s10, 4
    s_lshr_b32 s70, s70, s10
    s_lshl_b32 s70, s70, 16
    s_lshr_b32 s71, s71, s10
    s_lshl_b32 s71, s71, 16
    v_mov_b32 v26, s70
    v_mov_b32 v27, s71
    s_mov_b32 s11, 0x3fb8aa3b
    v_mul_f32 v6, s11, v26
    v_fma_f32 v7, v26, s11, -v6
    v_fmac_f32 v7, 0x32a57060, v26
    v_exp_f32 v6, v6
    v_mul_f32 v7, 0x3f317218, v7
    v_fmac_f32 v6, v6, v7
    v_cvt_pk_bf16_f32 v26, 0, v6
    s_waitcnt vmcnt(4)
    v_alignbit_b32 v9, v41, v40, v3
    v_lshlrev_b32 v10, v4, v41
    v_lshlrev_b32 v8, 16, v9
    v_and_b32 v9, s12, v9
    v_and_b32 v10, s12, v10
    v_alignbit_b32 v12, v43, v42, v3
    v_lshlrev_b32 v13, v4, v43
    v_lshlrev_b32 v11, 16, v12
    v_and_b32 v12, s12, v12
    v_and_b32 v13, s12, v13
    v_mul_f32 v8, v26, v8
    v_mul_f32 v11, v26, v11
    v_mul_f32 v9, v26, v9
    v_mul_f32 v12, v26, v12
    v_mul_f32 v10, v26, v10
    v_mul_f32 v13, v26, v13
    v_mul_f32 v8, s11, v8
    v_mul_f32 v11, 0.15915494309189535, v11
    v_mul_f32 v9, s11, v9
    v_mul_f32 v12, 0.15915494309189535, v12
    v_mul_f32 v10, s11, v10
    v_mul_f32 v13, 0.15915494309189535, v13
    v_fract_f32 v52, v11
    v_exp_f32 v53, v8
    v_fract_f32 v54, v12
    v_exp_f32 v55, v9
    v_fract_f32 v56, v13
    v_exp_f32 v57, v10
    v_cos_f32 v58, v52
    v_sin_f32 v59, v52
    v_cos_f32 v60, v54
    v_sin_f32 v61, v54
    v_cos_f32 v62, v56
    v_sin_f32 v63, v56
    v_mul_f32 v58, v58, v53
    v_mul_f32 v59, v59, v53
    v_mul_f32 v60, v60, v55
    v_mul_f32 v61, v61, v55
    v_mul_f32 v62, v62, v57
    v_mul_f32 v63, v63, v57
    v_cvt_pk_bf16_f32 v28, v58, v59
    v_cvt_pk_bf16_f32 v29, v60, v61
    v_cvt_pk_bf16_f32 v30, v62, v63
    ds_write_addtid_b32 v28 offset:800
    ds_write_addtid_b32 v29 offset:1056
    ds_write_addtid_b32 v30 offset:1312
    v_mul_f32 v64, v58, v58
    v_mul_f32 v66, v60, v60
    v_mul_f32 v68, v62, v62
    v_mul_f32 v65, v58, v59
    v_mul_f32 v67, v60, v61
    v_mul_f32 v69, v62, v63
    v_fma_f32 v64, -v59, v59, v64
    v_fma_f32 v66, -v61, v61, v66
    v_fma_f32 v68, -v63, v63, v68
    v_fmac_f32 v65, v59, v58
    v_fmac_f32 v67, v61, v60
    v_fmac_f32 v69, v63, v62
    v_cvt_pk_bf16_f32 v28, v64, v65
    v_cvt_pk_bf16_f32 v29, v66, v67
    v_cvt_pk_bf16_f32 v30, v68, v69
    ds_write_addtid_b32 v28 offset:1600
    ds_write_addtid_b32 v29 offset:1856
    ds_write_addtid_b32 v30 offset:2112
    v_mul_f32 v94, v64, v58
    v_mul_f32 v96, v66, v60
    v_mul_f32 v98, v68, v62
    v_mul_f32 v95, v64, v59
    v_mul_f32 v97, v66, v61
    v_mul_f32 v99, v68, v63
    v_fma_f32 v94, -v65, v59, v94
    v_fma_f32 v96, -v67, v61, v96
    v_fma_f32 v98, -v69, v63, v98
    v_fmac_f32 v95, v65, v58
    v_fmac_f32 v97, v67, v60
    v_fmac_f32 v99, v69, v62
    v_cvt_pk_bf16_f32 v28, v94, v95
    v_cvt_pk_bf16_f32 v29, v96, v97
    v_cvt_pk_bf16_f32 v30, v98, v99
    ds_write_addtid_b32 v28 offset:2400
    ds_write_addtid_b32 v29 offset:2656
    ds_write_addtid_b32 v30 offset:2912
    v_mul_f32 v70, v94, v58
    v_mul_f32 v72, v96, v60
    v_mul_f32 v74, v98, v62
    v_mul_f32 v71, v94, v59
    v_mul_f32 v73, v96, v61
    v_mul_f32 v75, v98, v63
    v_fma_f32 v70, -v95, v59, v70
    v_fma_f32 v72, -v97, v61, v72
    v_fma_f32 v74, -v99, v63, v74
    v_fmac_f32 v71, v95, v58
    v_fmac_f32 v73, v97, v60
    v_fmac_f32 v75, v99, v62
    v_cvt_pk_bf16_f32 v28, v70, v71
    v_cvt_pk_bf16_f32 v29, v72, v73
    v_cvt_pk_bf16_f32 v30, v74, v75
    ds_write_addtid_b32 v28 offset:3200
    ds_write_addtid_b32 v29 offset:3456
    ds_write_addtid_b32 v30 offset:3712
    v_mul_f32 v94, v70, v58
    v_mul_f32 v96, v72, v60
    v_mul_f32 v98, v74, v62
    v_mul_f32 v95, v70, v59
    v_mul_f32 v97, v72, v61
    v_mul_f32 v99, v74, v63
    v_fma_f32 v94, -v71, v59, v94
    v_fma_f32 v96, -v73, v61, v96
    v_fma_f32 v98, -v75, v63, v98
    v_fmac_f32 v95, v71, v58
    v_fmac_f32 v97, v73, v60
    v_fmac_f32 v99, v75, v62
    v_cvt_pk_bf16_f32 v28, v94, v95
    v_cvt_pk_bf16_f32 v29, v96, v97
    v_cvt_pk_bf16_f32 v30, v98, v99
    ds_write_addtid_b32 v28 offset:4000
    ds_write_addtid_b32 v29 offset:4256
    ds_write_addtid_b32 v30 offset:4512
    v_mul_f32 v100, v94, v58
    v_mul_f32 v102, v96, v60
    v_mul_f32 v104, v98, v62
    v_mul_f32 v101, v94, v59
    v_mul_f32 v103, v96, v61
    v_mul_f32 v105, v98, v63
    v_fma_f32 v100, -v95, v59, v100
    v_fma_f32 v102, -v97, v61, v102
    v_fma_f32 v104, -v99, v63, v104
    v_fmac_f32 v101, v95, v58
    v_fmac_f32 v103, v97, v60
    v_fmac_f32 v105, v99, v62
    v_cvt_pk_bf16_f32 v28, v100, v101
    v_cvt_pk_bf16_f32 v29, v102, v103
    v_cvt_pk_bf16_f32 v30, v104, v105
    ds_write_addtid_b32 v28 offset:4800
    ds_write_addtid_b32 v29 offset:5056
    ds_write_addtid_b32 v30 offset:5312
    v_mul_f32 v94, v100, v58
    v_mul_f32 v96, v102, v60
    v_mul_f32 v98, v104, v62
    v_mul_f32 v95, v100, v59
    v_mul_f32 v97, v102, v61
    v_mul_f32 v99, v104, v63
    v_fma_f32 v94, -v101, v59, v94
    v_fma_f32 v96, -v103, v61, v96
    v_fma_f32 v98, -v105, v63, v98
    v_fmac_f32 v95, v101, v58
    v_fmac_f32 v97, v103, v60
    v_fmac_f32 v99, v105, v62
    v_cvt_pk_bf16_f32 v28, v94, v95
    v_cvt_pk_bf16_f32 v29, v96, v97
    v_cvt_pk_bf16_f32 v30, v98, v99
    ds_write_addtid_b32 v28 offset:5600
    ds_write_addtid_b32 v29 offset:5856
    ds_write_addtid_b32 v30 offset:6112
    v_mul_f32 v76, v94, v58
    v_mul_f32 v78, v96, v60
    v_mul_f32 v80, v98, v62
    v_mul_f32 v77, v94, v59
    v_mul_f32 v79, v96, v61
    v_mul_f32 v81, v98, v63
    v_fma_f32 v76, -v95, v59, v76
    v_fma_f32 v78, -v97, v61, v78
    v_fma_f32 v80, -v99, v63, v80
    v_fmac_f32 v77, v95, v58
    v_fmac_f32 v79, v97, v60
    v_fmac_f32 v81, v99, v62
    v_cvt_pk_bf16_f32 v28, v76, v77
    v_cvt_pk_bf16_f32 v29, v78, v79
    v_cvt_pk_bf16_f32 v30, v80, v81
    ds_write_addtid_b32 v28 offset:6400
    ds_write_addtid_b32 v29 offset:6656
    ds_write_addtid_b32 v30 offset:6912
    v_mul_f32 v94, v76, v58
    v_mul_f32 v96, v78, v60
    v_mul_f32 v98, v80, v62
    v_mul_f32 v95, v76, v59
    v_mul_f32 v97, v78, v61
    v_mul_f32 v99, v80, v63
    v_fma_f32 v94, -v77, v59, v94
    v_fma_f32 v96, -v79, v61, v96
    v_fma_f32 v98, -v81, v63, v98
    v_fmac_f32 v95, v77, v58
    v_fmac_f32 v97, v79, v60
    v_fmac_f32 v99, v81, v62
    v_cvt_pk_bf16_f32 v28, v94, v95
    v_cvt_pk_bf16_f32 v29, v96, v97
    v_cvt_pk_bf16_f32 v30, v98, v99
    ds_write_addtid_b32 v28 offset:7200
    ds_write_addtid_b32 v29 offset:7456
    ds_write_addtid_b32 v30 offset:7712
    v_mul_f32 v100, v94, v58
    v_mul_f32 v102, v96, v60
    v_mul_f32 v104, v98, v62
    v_mul_f32 v101, v94, v59
    v_mul_f32 v103, v96, v61
    v_mul_f32 v105, v98, v63
    v_fma_f32 v100, -v95, v59, v100
    v_fma_f32 v102, -v97, v61, v102
    v_fma_f32 v104, -v99, v63, v104
    v_fmac_f32 v101, v95, v58
    v_fmac_f32 v103, v97, v60
    v_fmac_f32 v105, v99, v62
    v_cvt_pk_bf16_f32 v28, v100, v101
    v_cvt_pk_bf16_f32 v29, v102, v103
    v_cvt_pk_bf16_f32 v30, v104, v105
    ds_write_addtid_b32 v28 offset:8000
    ds_write_addtid_b32 v29 offset:8256
    ds_write_addtid_b32 v30 offset:8512
    v_mul_f32 v94, v100, v58
    v_mul_f32 v96, v102, v60
    v_mul_f32 v98, v104, v62
    v_mul_f32 v95, v100, v59
    v_mul_f32 v97, v102, v61
    v_mul_f32 v99, v104, v63
    v_fma_f32 v94, -v101, v59, v94
    v_fma_f32 v96, -v103, v61, v96
    v_fma_f32 v98, -v105, v63, v98
    v_fmac_f32 v95, v101, v58
    v_fmac_f32 v97, v103, v60
    v_fmac_f32 v99, v105, v62
    v_cvt_pk_bf16_f32 v28, v94, v95
    v_cvt_pk_bf16_f32 v29, v96, v97
    v_cvt_pk_bf16_f32 v30, v98, v99
    ds_write_addtid_b32 v28 offset:8800
    ds_write_addtid_b32 v29 offset:9056
    ds_write_addtid_b32 v30 offset:9312
    v_mul_f32 v82, v94, v58
    v_mul_f32 v84, v96, v60
    v_mul_f32 v86, v98, v62
    v_mul_f32 v83, v94, v59
    v_mul_f32 v85, v96, v61
    v_mul_f32 v87, v98, v63
    v_fma_f32 v82, -v95, v59, v82
    v_fma_f32 v84, -v97, v61, v84
    v_fma_f32 v86, -v99, v63, v86
    v_fmac_f32 v83, v95, v58
    v_fmac_f32 v85, v97, v60
    v_fmac_f32 v87, v99, v62
    v_cvt_pk_bf16_f32 v28, v82, v83
    v_cvt_pk_bf16_f32 v29, v84, v85
    v_cvt_pk_bf16_f32 v30, v86, v87
    ds_write_addtid_b32 v28 offset:9600
    ds_write_addtid_b32 v29 offset:9856
    ds_write_addtid_b32 v30 offset:10112
    v_mul_f32 v94, v82, v58
    v_mul_f32 v96, v84, v60
    v_mul_f32 v98, v86, v62
    v_mul_f32 v95, v82, v59
    v_mul_f32 v97, v84, v61
    v_mul_f32 v99, v86, v63
    v_fma_f32 v94, -v83, v59, v94
    v_fma_f32 v96, -v85, v61, v96
    v_fma_f32 v98, -v87, v63, v98
    v_fmac_f32 v95, v83, v58
    v_fmac_f32 v97, v85, v60
    v_fmac_f32 v99, v87, v62
    v_cvt_pk_bf16_f32 v28, v94, v95
    v_cvt_pk_bf16_f32 v29, v96, v97
    v_cvt_pk_bf16_f32 v30, v98, v99
    ds_write_addtid_b32 v28 offset:10400
    ds_write_addtid_b32 v29 offset:10656
    ds_write_addtid_b32 v30 offset:10912
    v_mul_f32 v100, v94, v58
    v_mul_f32 v102, v96, v60
    v_mul_f32 v104, v98, v62
    v_mul_f32 v101, v94, v59
    v_mul_f32 v103, v96, v61
    v_mul_f32 v105, v98, v63
    v_fma_f32 v100, -v95, v59, v100
    v_fma_f32 v102, -v97, v61, v102
    v_fma_f32 v104, -v99, v63, v104
    v_fmac_f32 v101, v95, v58
    v_fmac_f32 v103, v97, v60
    v_fmac_f32 v105, v99, v62
    v_cvt_pk_bf16_f32 v28, v100, v101
    v_cvt_pk_bf16_f32 v29, v102, v103
    v_cvt_pk_bf16_f32 v30, v104, v105
    ds_write_addtid_b32 v28 offset:11200
    ds_write_addtid_b32 v29 offset:11456
    ds_write_addtid_b32 v30 offset:11712
    v_mul_f32 v94, v100, v58
    v_mul_f32 v96, v102, v60
    v_mul_f32 v98, v104, v62
    v_mul_f32 v95, v100, v59
    v_mul_f32 v97, v102, v61
    v_mul_f32 v99, v104, v63
    v_fma_f32 v94, -v101, v59, v94
    v_fma_f32 v96, -v103, v61, v96
    v_fma_f32 v98, -v105, v63, v98
    v_fmac_f32 v95, v101, v58
    v_fmac_f32 v97, v103, v60
    v_fmac_f32 v99, v105, v62
    v_cvt_pk_bf16_f32 v28, v94, v95
    v_cvt_pk_bf16_f32 v29, v96, v97
    v_cvt_pk_bf16_f32 v30, v98, v99
    ds_write_addtid_b32 v28 offset:12000
    ds_write_addtid_b32 v29 offset:12256
    ds_write_addtid_b32 v30 offset:12512
    v_mul_f32 v88, v94, v58
    v_mul_f32 v90, v96, v60
    v_mul_f32 v92, v98, v62
    v_mul_f32 v89, v94, v59
    v_mul_f32 v91, v96, v61
    v_mul_f32 v93, v98, v63
    v_fma_f32 v88, -v95, v59, v88
    v_fma_f32 v90, -v97, v61, v90
    v_fma_f32 v92, -v99, v63, v92
    v_fmac_f32 v89, v95, v58
    v_fmac_f32 v91, v97, v60
    v_fmac_f32 v93, v99, v62
    ds_read_b128 v[128:131], v5 offset:0
    ds_read_b128 v[132:135], v5 offset:64
    ds_read_b128 v[136:139], v5 offset:128
    ds_read_b128 v[140:143], v5 offset:192
    ds_read_b128 v[144:147], v5 offset:256
    ds_read_b128 v[148:151], v5 offset:320
    ds_read_b128 v[152:155], v5 offset:384
    ds_read_b128 v[156:159], v5 offset:448
    ds_read_b128 v[160:163], v5 offset:512
    ds_read_b128 v[164:167], v5 offset:576
    ds_read_b128 v[168:171], v5 offset:640
    ds_read_b128 v[172:175], v5 offset:704
    s_waitcnt vmcnt(0)
    v_alignbit_b32 v15, v45, v44, v3
    v_lshlrev_b32 v16, v4, v45
    v_lshlrev_b32 v14, 16, v15
    v_and_b32 v15, s12, v15
    v_and_b32 v16, s12, v16
    v_alignbit_b32 v18, v47, v46, v3
    v_lshlrev_b32 v19, v4, v47
    v_lshlrev_b32 v17, 16, v18
    v_and_b32 v18, s12, v18
    v_and_b32 v19, s12, v19
    v_alignbit_b32 v21, v49, v48, v3
    v_lshlrev_b32 v22, v4, v49
    v_lshlrev_b32 v20, 16, v21
    v_and_b32 v21, s12, v21
    v_and_b32 v22, s12, v22
    v_alignbit_b32 v24, v51, v50, v3
    v_lshlrev_b32 v25, v4, v51
    v_lshlrev_b32 v23, 16, v24
    v_and_b32 v24, s12, v24
    v_and_b32 v25, s12, v25
    v_mul_f32 v14, v26, v14
    v_mul_f32 v17, v26, v17
    v_mul_f32 v15, v26, v15
    v_mul_f32 v18, v26, v18
    v_mul_f32 v16, v26, v16
    v_mul_f32 v19, v26, v19
    v_mul_f32 v94, v20, v14
    v_mul_f32 v95, v20, v17
    v_mul_f32 v96, v21, v15
    v_mul_f32 v97, v21, v18
    v_mul_f32 v98, v22, v16
    v_mul_f32 v99, v22, v19
    v_fma_f32 v94, -v23, v17, v94
    v_fma_f32 v95, -v23, v14, -v95
    v_fma_f32 v96, -v24, v18, v96
    v_fma_f32 v97, -v24, v15, -v97
    v_fma_f32 v98, -v25, v19, v98
    v_fma_f32 v99, -v25, v16, -v99
    v_cvt_pk_bf16_f32 v28, v94, v95
    v_cvt_pk_bf16_f32 v29, v96, v97
    v_cvt_pk_bf16_f32 v30, v98, v99
    ds_write_addtid_b32 v28 offset:0
    ds_write_addtid_b32 v29 offset:256
    ds_write_addtid_b32 v30 offset:512
    v_mul_f32 v100, v94, v88
    v_mul_f32 v102, v96, v90
    v_mul_f32 v104, v98, v92
    v_mul_f32 v101, v95, v88
    v_mul_f32 v103, v97, v90
    v_mul_f32 v105, v99, v92
    v_fmac_f32 v100, v95, v89
    v_fmac_f32 v102, v97, v91
    v_fmac_f32 v104, v99, v93
    v_fma_f32 v101, -v94, v89, v101
    v_fma_f32 v103, -v96, v91, v103
    v_fma_f32 v105, -v98, v93, v105
    v_cvt_pk_bf16_f32 v28, v100, v101
    v_cvt_pk_bf16_f32 v29, v102, v103
    v_cvt_pk_bf16_f32 v30, v104, v105
    ds_write_addtid_b32 v28 offset:800
    ds_write_addtid_b32 v29 offset:1056
    ds_write_addtid_b32 v30 offset:1312
    v_mul_f32 v94, v100, v88
    v_mul_f32 v96, v102, v90
    v_mul_f32 v98, v104, v92
    v_mul_f32 v95, v101, v88
    v_mul_f32 v97, v103, v90
    v_mul_f32 v99, v105, v92
    v_fmac_f32 v94, v101, v89
    v_fmac_f32 v96, v103, v91
    v_fmac_f32 v98, v105, v93
    v_fma_f32 v95, -v100, v89, v95
    v_fma_f32 v97, -v102, v91, v97
    v_fma_f32 v99, -v104, v93, v99
    v_cvt_pk_bf16_f32 v28, v94, v95
    v_cvt_pk_bf16_f32 v29, v96, v97
    v_cvt_pk_bf16_f32 v30, v98, v99
    ds_write_addtid_b32 v28 offset:1600
    ds_write_addtid_b32 v29 offset:1856
    ds_write_addtid_b32 v30 offset:2112
    v_mul_f32 v100, v94, v88
    v_mul_f32 v102, v96, v90
    v_mul_f32 v104, v98, v92
    v_mul_f32 v101, v95, v88
    v_mul_f32 v103, v97, v90
    v_mul_f32 v105, v99, v92
    v_fmac_f32 v100, v95, v89
    v_fmac_f32 v102, v97, v91
    v_fmac_f32 v104, v99, v93
    v_fma_f32 v101, -v94, v89, v101
    v_fma_f32 v103, -v96, v91, v103
    v_fma_f32 v105, -v98, v93, v105
    v_cvt_pk_bf16_f32 v28, v100, v101
    v_cvt_pk_bf16_f32 v29, v102, v103
    v_cvt_pk_bf16_f32 v30, v104, v105
    ds_write_addtid_b32 v28 offset:2400
    ds_write_addtid_b32 v29 offset:2656
    ds_write_addtid_b32 v30 offset:2912
    v_mul_f32 v94, v100, v88
    v_mul_f32 v96, v102, v90
    v_mul_f32 v98, v104, v92
    v_mul_f32 v95, v101, v88
    v_mul_f32 v97, v103, v90
    v_mul_f32 v99, v105, v92
    v_fmac_f32 v94, v101, v89
    v_fmac_f32 v96, v103, v91
    v_fmac_f32 v98, v105, v93
    v_fma_f32 v95, -v100, v89, v95
    v_fma_f32 v97, -v102, v91, v97
    v_fma_f32 v99, -v104, v93, v99
    v_cvt_pk_bf16_f32 v28, v94, v95
    v_cvt_pk_bf16_f32 v29, v96, v97
    v_cvt_pk_bf16_f32 v30, v98, v99
    ds_write_addtid_b32 v28 offset:3200
    ds_write_addtid_b32 v29 offset:3456
    ds_write_addtid_b32 v30 offset:3712
    v_mul_f32 v100, v94, v88
    v_mul_f32 v102, v96, v90
    v_mul_f32 v104, v98, v92
    v_mul_f32 v101, v95, v88
    v_mul_f32 v103, v97, v90
    v_mul_f32 v105, v99, v92
    v_fmac_f32 v100, v95, v89
    v_fmac_f32 v102, v97, v91
    v_fmac_f32 v104, v99, v93
    v_fma_f32 v101, -v94, v89, v101
    v_fma_f32 v103, -v96, v91, v103
    v_fma_f32 v105, -v98, v93, v105
    v_cvt_pk_bf16_f32 v28, v100, v101
    v_cvt_pk_bf16_f32 v29, v102, v103
    v_cvt_pk_bf16_f32 v30, v104, v105
    ds_write_addtid_b32 v28 offset:4000
    ds_write_addtid_b32 v29 offset:4256
    ds_write_addtid_b32 v30 offset:4512
    v_mul_f32 v94, v100, v88
    v_mul_f32 v96, v102, v90
    v_mul_f32 v98, v104, v92
    v_mul_f32 v95, v101, v88
    v_mul_f32 v97, v103, v90
    v_mul_f32 v99, v105, v92
    v_fmac_f32 v94, v101, v89
    v_fmac_f32 v96, v103, v91
    v_fmac_f32 v98, v105, v93
    v_fma_f32 v95, -v100, v89, v95
    v_fma_f32 v97, -v102, v91, v97
    v_fma_f32 v99, -v104, v93, v99
    v_cvt_pk_bf16_f32 v28, v94, v95
    v_cvt_pk_bf16_f32 v29, v96, v97
    v_cvt_pk_bf16_f32 v30, v98, v99
    ds_write_addtid_b32 v28 offset:4800
    ds_write_addtid_b32 v29 offset:5056
    ds_write_addtid_b32 v30 offset:5312
    v_mul_f32 v100, v94, v88
    v_mul_f32 v102, v96, v90
    v_mul_f32 v104, v98, v92
    v_mul_f32 v101, v95, v88
    v_mul_f32 v103, v97, v90
    v_mul_f32 v105, v99, v92
    v_fmac_f32 v100, v95, v89
    v_fmac_f32 v102, v97, v91
    v_fmac_f32 v104, v99, v93
    v_fma_f32 v101, -v94, v89, v101
    v_fma_f32 v103, -v96, v91, v103
    v_fma_f32 v105, -v98, v93, v105
    v_cvt_pk_bf16_f32 v28, v100, v101
    v_cvt_pk_bf16_f32 v29, v102, v103
    v_cvt_pk_bf16_f32 v30, v104, v105
    ds_write_addtid_b32 v28 offset:5600
    ds_write_addtid_b32 v29 offset:5856
    ds_write_addtid_b32 v30 offset:6112
    v_mul_f32 v94, v100, v88
    v_mul_f32 v96, v102, v90
    v_mul_f32 v98, v104, v92
    v_mul_f32 v95, v101, v88
    v_mul_f32 v97, v103, v90
    v_mul_f32 v99, v105, v92
    v_fmac_f32 v94, v101, v89
    v_fmac_f32 v96, v103, v91
    v_fmac_f32 v98, v105, v93
    v_fma_f32 v95, -v100, v89, v95
    v_fma_f32 v97, -v102, v91, v97
    v_fma_f32 v99, -v104, v93, v99
    v_cvt_pk_bf16_f32 v28, v94, v95
    v_cvt_pk_bf16_f32 v29, v96, v97
    v_cvt_pk_bf16_f32 v30, v98, v99
    ds_write_addtid_b32 v28 offset:6400
    ds_write_addtid_b32 v29 offset:6656
    ds_write_addtid_b32 v30 offset:6912
    v_mul_f32 v100, v94, v88
    v_mul_f32 v102, v96, v90
    v_mul_f32 v104, v98, v92
    v_mul_f32 v101, v95, v88
    v_mul_f32 v103, v97, v90
    v_mul_f32 v105, v99, v92
    v_fmac_f32 v100, v95, v89
    v_fmac_f32 v102, v97, v91
    v_fmac_f32 v104, v99, v93
    v_fma_f32 v101, -v94, v89, v101
    v_fma_f32 v103, -v96, v91, v103
    v_fma_f32 v105, -v98, v93, v105
    v_cvt_pk_bf16_f32 v28, v100, v101
    v_cvt_pk_bf16_f32 v29, v102, v103
    v_cvt_pk_bf16_f32 v30, v104, v105
    ds_write_addtid_b32 v28 offset:7200
    ds_write_addtid_b32 v29 offset:7456
    ds_write_addtid_b32 v30 offset:7712
    v_mul_f32 v94, v100, v88
    v_mul_f32 v96, v102, v90
    v_mul_f32 v98, v104, v92
    v_mul_f32 v95, v101, v88
    v_mul_f32 v97, v103, v90
    v_mul_f32 v99, v105, v92
    v_fmac_f32 v94, v101, v89
    v_fmac_f32 v96, v103, v91
    v_fmac_f32 v98, v105, v93
    v_fma_f32 v95, -v100, v89, v95
    v_fma_f32 v97, -v102, v91, v97
    v_fma_f32 v99, -v104, v93, v99
    v_cvt_pk_bf16_f32 v28, v94, v95
    v_cvt_pk_bf16_f32 v29, v96, v97
    v_cvt_pk_bf16_f32 v30, v98, v99
    ds_write_addtid_b32 v28 offset:8000
    ds_write_addtid_b32 v29 offset:8256
    ds_write_addtid_b32 v30 offset:8512
    v_mul_f32 v100, v94, v88
    v_mul_f32 v102, v96, v90
    v_mul_f32 v104, v98, v92
    v_mul_f32 v101, v95, v88
    v_mul_f32 v103, v97, v90
    v_mul_f32 v105, v99, v92
    v_fmac_f32 v100, v95, v89
    v_fmac_f32 v102, v97, v91
    v_fmac_f32 v104, v99, v93
    v_fma_f32 v101, -v94, v89, v101
    v_fma_f32 v103, -v96, v91, v103
    v_fma_f32 v105, -v98, v93, v105
    v_cvt_pk_bf16_f32 v28, v100, v101
    v_cvt_pk_bf16_f32 v29, v102, v103
    v_cvt_pk_bf16_f32 v30, v104, v105
    ds_write_addtid_b32 v28 offset:8800
    ds_write_addtid_b32 v29 offset:9056
    ds_write_addtid_b32 v30 offset:9312
    v_mul_f32 v94, v100, v88
    v_mul_f32 v96, v102, v90
    v_mul_f32 v98, v104, v92
    v_mul_f32 v95, v101, v88
    v_mul_f32 v97, v103, v90
    v_mul_f32 v99, v105, v92
    v_fmac_f32 v94, v101, v89
    v_fmac_f32 v96, v103, v91
    v_fmac_f32 v98, v105, v93
    v_fma_f32 v95, -v100, v89, v95
    v_fma_f32 v97, -v102, v91, v97
    v_fma_f32 v99, -v104, v93, v99
    v_cvt_pk_bf16_f32 v28, v94, v95
    v_cvt_pk_bf16_f32 v29, v96, v97
    v_cvt_pk_bf16_f32 v30, v98, v99
    ds_write_addtid_b32 v28 offset:9600
    ds_write_addtid_b32 v29 offset:9856
    ds_write_addtid_b32 v30 offset:10112
    v_mul_f32 v100, v94, v88
    v_mul_f32 v102, v96, v90
    v_mul_f32 v104, v98, v92
    v_mul_f32 v101, v95, v88
    v_mul_f32 v103, v97, v90
    v_mul_f32 v105, v99, v92
    v_fmac_f32 v100, v95, v89
    v_fmac_f32 v102, v97, v91
    v_fmac_f32 v104, v99, v93
    v_fma_f32 v101, -v94, v89, v101
    v_fma_f32 v103, -v96, v91, v103
    v_fma_f32 v105, -v98, v93, v105
    v_cvt_pk_bf16_f32 v28, v100, v101
    v_cvt_pk_bf16_f32 v29, v102, v103
    v_cvt_pk_bf16_f32 v30, v104, v105
    ds_write_addtid_b32 v28 offset:10400
    ds_write_addtid_b32 v29 offset:10656
    ds_write_addtid_b32 v30 offset:10912
    v_mul_f32 v94, v100, v88
    v_mul_f32 v96, v102, v90
    v_mul_f32 v98, v104, v92
    v_mul_f32 v95, v101, v88
    v_mul_f32 v97, v103, v90
    v_mul_f32 v99, v105, v92
    v_fmac_f32 v94, v101, v89
    v_fmac_f32 v96, v103, v91
    v_fmac_f32 v98, v105, v93
    v_fma_f32 v95, -v100, v89, v95
    v_fma_f32 v97, -v102, v91, v97
    v_fma_f32 v99, -v104, v93, v99
    v_cvt_pk_bf16_f32 v28, v94, v95
    v_cvt_pk_bf16_f32 v29, v96, v97
    v_cvt_pk_bf16_f32 v30, v98, v99
    ds_write_addtid_b32 v28 offset:11200
    ds_write_addtid_b32 v29 offset:11456
    ds_write_addtid_b32 v30 offset:11712
    v_mul_f32 v100, v94, v88
    v_mul_f32 v102, v96, v90
    v_mul_f32 v104, v98, v92
    v_mul_f32 v101, v95, v88
    v_mul_f32 v103, v97, v90
    v_mul_f32 v105, v99, v92
    v_fmac_f32 v100, v95, v89
    v_fmac_f32 v102, v97, v91
    v_fmac_f32 v104, v99, v93
    v_fma_f32 v101, -v94, v89, v101
    v_fma_f32 v103, -v96, v91, v103
    v_fma_f32 v105, -v98, v93, v105
    v_cvt_pk_bf16_f32 v28, v100, v101
    v_cvt_pk_bf16_f32 v29, v102, v103
    v_cvt_pk_bf16_f32 v30, v104, v105
    ds_write_addtid_b32 v28 offset:12000
    ds_write_addtid_b32 v29 offset:12256
    ds_write_addtid_b32 v30 offset:12512
    ds_read_b128 v[176:179], v5 offset:0
    ds_read_b128 v[180:183], v5 offset:64
    ds_read_b128 v[184:187], v5 offset:128
    ds_read_b128 v[188:191], v5 offset:192
    ds_read_b128 v[192:195], v5 offset:256
    ds_read_b128 v[196:199], v5 offset:320
    ds_read_b128 v[200:203], v5 offset:384
    ds_read_b128 v[204:207], v5 offset:448
    ds_read_b128 v[208:211], v5 offset:512
    ds_read_b128 v[212:215], v5 offset:576
    ds_read_b128 v[216:219], v5 offset:640
    ds_read_b128 v[220:223], v5 offset:704
    v_mul_f32 v52, 0x43800000, v11
    v_mul_f32 v53, 0x43800000, v8
    v_mul_f32 v54, 0x43800000, v12
    v_mul_f32 v55, 0x43800000, v9
    v_mul_f32 v56, 0x43800000, v13
    v_mul_f32 v57, 0x43800000, v10
    v_fract_f32 v52, v52
    v_exp_f32 v53, v53
    v_fract_f32 v54, v54
    v_exp_f32 v55, v55
    v_fract_f32 v56, v56
    v_exp_f32 v57, v57
    v_cos_f32 v106, v52
    v_sin_f32 v107, v52
    v_cos_f32 v108, v54
    v_sin_f32 v109, v54
    v_cos_f32 v110, v56
    v_sin_f32 v111, v56
    v_mul_f32 v106, v106, v53
    v_mul_f32 v107, v107, v53
    v_mul_f32 v108, v108, v55
    v_mul_f32 v109, v109, v55
    v_mul_f32 v110, v110, v57
    v_mul_f32 v111, v111, v57
    v_cvt_pk_bf16_f32 v28, v106, v107
    v_cvt_pk_bf16_f32 v29, v108, v109
    v_cvt_pk_bf16_f32 v30, v110, v111
    s_waitcnt lgkmcnt(0)
    v_mfma_f32_16x16x32_bf16 v[224:227], v[128:131], v[176:179], 0
    ds_write_addtid_b32 v28 offset:0
    ds_write_addtid_b32 v29 offset:256
    ds_write_addtid_b32 v30 offset:512
    v_mul_f32 v94, v106, v64
    v_mul_f32 v96, v108, v66
    v_mfma_f32_16x16x32_bf16 v[224:227], v[132:135], v[180:183], v[224:227]
    v_mul_f32 v98, v110, v68
    v_mul_f32 v95, v106, v65
    v_mul_f32 v97, v108, v67
    v_mul_f32 v99, v110, v69
    v_fma_f32 v94, -v107, v65, v94
    v_mfma_f32_16x16x32_bf16 v[224:227], v[136:139], v[184:187], v[224:227]
    v_fma_f32 v96, -v109, v67, v96
    v_fma_f32 v98, -v111, v69, v98
    v_fmac_f32 v95, v107, v64
    v_fmac_f32 v97, v109, v66
    v_fmac_f32 v99, v111, v68
    v_mfma_f32_16x16x32_bf16 v[224:227], v[140:143], v[188:191], v[224:227]
    v_cvt_pk_bf16_f32 v28, v94, v95
    v_cvt_pk_bf16_f32 v29, v96, v97
    v_cvt_pk_bf16_f32 v30, v98, v99
    ds_write_addtid_b32 v28 offset:800
    ds_write_addtid_b32 v29 offset:1056
    v_mfma_f32_16x16x32_bf16 v[224:227], v[144:147], v[192:195], v[224:227]
    ds_write_addtid_b32 v30 offset:1312
    v_mul_f32 v100, v94, v64
    v_mul_f32 v102, v96, v66
    v_mul_f32 v104, v98, v68
    v_mul_f32 v101, v94, v65
    v_mfma_f32_16x16x32_bf16 v[224:227], v[148:151], v[196:199], v[224:227]
    v_mul_f32 v103, v96, v67
    v_mul_f32 v105, v98, v69
    v_fma_f32 v100, -v95, v65, v100
    v_fma_f32 v102, -v97, v67, v102
    v_fma_f32 v104, -v99, v69, v104
    v_mfma_f32_16x16x32_bf16 v[224:227], v[152:155], v[200:203], v[224:227]
    v_fmac_f32 v101, v95, v64
    v_fmac_f32 v103, v97, v66
    v_fmac_f32 v105, v99, v68
    v_cvt_pk_bf16_f32 v28, v100, v101
    v_cvt_pk_bf16_f32 v29, v102, v103
    v_mfma_f32_16x16x32_bf16 v[224:227], v[156:159], v[204:207], v[224:227]
    v_cvt_pk_bf16_f32 v30, v104, v105
    ds_write_addtid_b32 v28 offset:1600
    ds_write_addtid_b32 v29 offset:1856
    ds_write_addtid_b32 v30 offset:2112
    v_mul_f32 v94, v100, v64
    v_mfma_f32_16x16x32_bf16 v[224:227], v[160:163], v[208:211], v[224:227]
    v_mul_f32 v96, v102, v66
    v_mul_f32 v98, v104, v68
    v_mul_f32 v95, v100, v65
    v_mul_f32 v97, v102, v67
    v_mul_f32 v99, v104, v69
    v_mfma_f32_16x16x32_bf16 v[224:227], v[164:167], v[212:215], v[224:227]
    v_fma_f32 v94, -v101, v65, v94
    v_fma_f32 v96, -v103, v67, v96
    v_fma_f32 v98, -v105, v69, v98
    v_fmac_f32 v95, v101, v64
    v_fmac_f32 v97, v103, v66
    v_mfma_f32_16x16x32_bf16 v[224:227], v[168:171], v[216:219], v[224:227]
    v_fmac_f32 v99, v105, v68
    v_cvt_pk_bf16_f32 v28, v94, v95
    v_cvt_pk_bf16_f32 v29, v96, v97
    v_cvt_pk_bf16_f32 v30, v98, v99
    ds_write_addtid_b32 v28 offset:2400
    v_mfma_f32_16x16x32_bf16 v[224:227], v[172:175], v[220:223], v[224:227]
    ds_write_addtid_b32 v29 offset:2656
    ds_write_addtid_b32 v30 offset:2912
    v_mul_f32 v100, v94, v64
    v_mul_f32 v102, v96, v66
    v_mul_f32 v104, v98, v68
    v_mul_f32 v101, v94, v65
    v_mul_f32 v103, v96, v67
    v_mul_f32 v105, v98, v69
    v_fma_f32 v100, -v95, v65, v100
    v_fma_f32 v102, -v97, v67, v102
    v_fma_f32 v104, -v99, v69, v104
    v_fmac_f32 v101, v95, v64
    v_fmac_f32 v103, v97, v66
    v_fmac_f32 v105, v99, v68
    v_cvt_pk_bf16_f32 v28, v100, v101
    v_cvt_pk_bf16_f32 v29, v102, v103
    v_cvt_pk_bf16_f32 v30, v104, v105
    ds_write_addtid_b32 v28 offset:3200
    ds_write_addtid_b32 v29 offset:3456
    ds_write_addtid_b32 v30 offset:3712
    v_mul_f32 v94, v100, v64
    v_mul_f32 v96, v102, v66
    v_mul_f32 v98, v104, v68
    v_mul_f32 v95, v100, v65
    v_mul_f32 v97, v102, v67
    v_mul_f32 v99, v104, v69
    v_fma_f32 v94, -v101, v65, v94
    v_fma_f32 v96, -v103, v67, v96
    v_fma_f32 v98, -v105, v69, v98
    v_fmac_f32 v95, v101, v64
    v_fmac_f32 v97, v103, v66
    v_fmac_f32 v99, v105, v68
    v_cvt_pk_bf16_f32 v28, v94, v95
    v_cvt_pk_bf16_f32 v29, v96, v97
    v_cvt_pk_bf16_f32 v30, v98, v99
    ds_write_addtid_b32 v28 offset:4000
    ds_write_addtid_b32 v29 offset:4256
    ds_write_addtid_b32 v30 offset:4512
    v_mul_f32 v100, v94, v64
    v_mul_f32 v102, v96, v66
    v_mul_f32 v104, v98, v68
    v_mul_f32 v101, v94, v65
    v_mul_f32 v103, v96, v67
    v_mul_f32 v105, v98, v69
    v_fma_f32 v100, -v95, v65, v100
    v_fma_f32 v102, -v97, v67, v102
    v_fma_f32 v104, -v99, v69, v104
    v_fmac_f32 v101, v95, v64
    v_fmac_f32 v103, v97, v66
    v_fmac_f32 v105, v99, v68
    v_cvt_pk_bf16_f32 v28, v100, v101
    v_cvt_pk_bf16_f32 v29, v102, v103
    v_cvt_pk_bf16_f32 v30, v104, v105
    ds_write_addtid_b32 v28 offset:4800
    ds_write_addtid_b32 v29 offset:5056
    ds_write_addtid_b32 v30 offset:5312
    v_mul_f32 v94, v100, v64
    v_mul_f32 v96, v102, v66
    v_mul_f32 v98, v104, v68
    v_mul_f32 v95, v100, v65
    v_mul_f32 v97, v102, v67
    v_mul_f32 v99, v104, v69
    v_fma_f32 v94, -v101, v65, v94
    v_fma_f32 v96, -v103, v67, v96
    v_fma_f32 v98, -v105, v69, v98
    v_fmac_f32 v95, v101, v64
    v_fmac_f32 v97, v103, v66
    v_fmac_f32 v99, v105, v68
    v_cvt_pk_bf16_f32 v28, v94, v95
    v_cvt_pk_bf16_f32 v29, v96, v97
    v_cvt_pk_bf16_f32 v30, v98, v99
    ds_write_addtid_b32 v28 offset:5600
    ds_write_addtid_b32 v29 offset:5856
    ds_write_addtid_b32 v30 offset:6112
    v_mul_f32 v112, v106, v106
    v_mul_f32 v114, v108, v108
    v_mul_f32 v116, v110, v110
    v_mul_f32 v113, v106, v107
    v_mul_f32 v115, v108, v109
    v_mul_f32 v117, v110, v111
    v_fma_f32 v112, -v107, v107, v112
    v_fma_f32 v114, -v109, v109, v114
    v_fma_f32 v116, -v111, v111, v116
    v_fmac_f32 v113, v107, v106
    v_fmac_f32 v115, v109, v108
    v_fmac_f32 v117, v111, v110
    v_cvt_pk_bf16_f32 v28, v112, v113
    v_cvt_pk_bf16_f32 v29, v114, v115
    v_cvt_pk_bf16_f32 v30, v116, v117
    ds_write_addtid_b32 v28 offset:6400
    ds_write_addtid_b32 v29 offset:6656
    ds_write_addtid_b32 v30 offset:6912
    v_mul_f32 v118, v112, v106
    v_mul_f32 v120, v114, v108
    v_mul_f32 v122, v116, v110
    v_mul_f32 v119, v112, v107
    v_mul_f32 v121, v114, v109
    v_mul_f32 v123, v116, v111
    v_fma_f32 v118, -v113, v107, v118
    v_fma_f32 v120, -v115, v109, v120
    v_fma_f32 v122, -v117, v111, v122
    v_fmac_f32 v119, v113, v106
    v_fmac_f32 v121, v115, v108
    v_fmac_f32 v123, v117, v110
    v_cvt_pk_bf16_f32 v28, v118, v119
    v_cvt_pk_bf16_f32 v29, v120, v121
    v_cvt_pk_bf16_f32 v30, v122, v123
    ds_write_addtid_b32 v28 offset:9600
    ds_write_addtid_b32 v29 offset:9856
    ds_write_addtid_b32 v30 offset:10112
    v_mul_f32 v94, v112, v70
    v_mul_f32 v96, v114, v72
    v_mul_f32 v98, v116, v74
    v_mul_f32 v95, v112, v71
    v_mul_f32 v97, v114, v73
    v_mul_f32 v99, v116, v75
    v_fma_f32 v94, -v113, v71, v94
    v_fma_f32 v96, -v115, v73, v96
    v_fma_f32 v98, -v117, v75, v98
    v_fmac_f32 v95, v113, v70
    v_fmac_f32 v97, v115, v72
    v_fmac_f32 v99, v117, v74
    v_cvt_pk_bf16_f32 v28, v94, v95
    v_cvt_pk_bf16_f32 v29, v96, v97
    v_cvt_pk_bf16_f32 v30, v98, v99
    ds_write_addtid_b32 v28 offset:7200
    ds_write_addtid_b32 v29 offset:7456
    ds_write_addtid_b32 v30 offset:7712
    v_mul_f32 v100, v112, v76
    v_mul_f32 v102, v114, v78
    v_mul_f32 v104, v116, v80
    v_mul_f32 v101, v112, v77
    v_mul_f32 v103, v114, v79
    v_mul_f32 v105, v116, v81
    v_fma_f32 v100, -v113, v77, v100
    v_fma_f32 v102, -v115, v79, v102
    v_fma_f32 v104, -v117, v81, v104
    v_fmac_f32 v101, v113, v76
    v_fmac_f32 v103, v115, v78
    v_fmac_f32 v105, v117, v80
    v_cvt_pk_bf16_f32 v28, v100, v101
    v_cvt_pk_bf16_f32 v29, v102, v103
    v_cvt_pk_bf16_f32 v30, v104, v105
    ds_write_addtid_b32 v28 offset:8000
    ds_write_addtid_b32 v29 offset:8256
    ds_write_addtid_b32 v30 offset:8512
    v_mul_f32 v94, v112, v82
    v_mul_f32 v96, v114, v84
    v_mul_f32 v98, v116, v86
    v_mul_f32 v95, v112, v83
    v_mul_f32 v97, v114, v85
    v_mul_f32 v99, v116, v87
    v_fma_f32 v94, -v113, v83, v94
    v_fma_f32 v96, -v115, v85, v96
    v_fma_f32 v98, -v117, v87, v98
    v_fmac_f32 v95, v113, v82
    v_fmac_f32 v97, v115, v84
    v_fmac_f32 v99, v117, v86
    v_cvt_pk_bf16_f32 v28, v94, v95
    v_cvt_pk_bf16_f32 v29, v96, v97
    v_cvt_pk_bf16_f32 v30, v98, v99
    ds_write_addtid_b32 v28 offset:8800
    ds_write_addtid_b32 v29 offset:9056
    ds_write_addtid_b32 v30 offset:9312
    v_mul_f32 v94, v118, v70
    v_mul_f32 v96, v120, v72
    v_mul_f32 v98, v122, v74
    v_mul_f32 v95, v118, v71
    v_mul_f32 v97, v120, v73
    v_mul_f32 v99, v122, v75
    v_fma_f32 v94, -v119, v71, v94
    v_fma_f32 v96, -v121, v73, v96
    v_fma_f32 v98, -v123, v75, v98
    v_fmac_f32 v95, v119, v70
    v_fmac_f32 v97, v121, v72
    v_fmac_f32 v99, v123, v74
    v_cvt_pk_bf16_f32 v28, v94, v95
    v_cvt_pk_bf16_f32 v29, v96, v97
    v_cvt_pk_bf16_f32 v30, v98, v99
    ds_write_addtid_b32 v28 offset:10400
    ds_write_addtid_b32 v29 offset:10656
    ds_write_addtid_b32 v30 offset:10912
    v_mul_f32 v100, v118, v76
    v_mul_f32 v102, v120, v78
    v_mul_f32 v104, v122, v80
    v_mul_f32 v101, v118, v77
    v_mul_f32 v103, v120, v79
    v_mul_f32 v105, v122, v81
    v_fma_f32 v100, -v119, v77, v100
    v_fma_f32 v102, -v121, v79, v102
    v_fma_f32 v104, -v123, v81, v104
    v_fmac_f32 v101, v119, v76
    v_fmac_f32 v103, v121, v78
    v_fmac_f32 v105, v123, v80
    v_cvt_pk_bf16_f32 v28, v100, v101
    v_cvt_pk_bf16_f32 v29, v102, v103
    v_cvt_pk_bf16_f32 v30, v104, v105
    ds_write_addtid_b32 v28 offset:11200
    ds_write_addtid_b32 v29 offset:11456
    ds_write_addtid_b32 v30 offset:11712
    v_mul_f32 v94, v118, v82
    v_mul_f32 v96, v120, v84
    v_mul_f32 v98, v122, v86
    v_mul_f32 v95, v118, v83
    v_mul_f32 v97, v120, v85
    v_mul_f32 v99, v122, v87
    v_fma_f32 v94, -v119, v83, v94
    v_fma_f32 v96, -v121, v85, v96
    v_fma_f32 v98, -v123, v87, v98
    v_fmac_f32 v95, v119, v82
    v_fmac_f32 v97, v121, v84
    v_fmac_f32 v99, v123, v86
    v_cvt_pk_bf16_f32 v28, v94, v95
    v_cvt_pk_bf16_f32 v29, v96, v97
    v_cvt_pk_bf16_f32 v30, v98, v99
    ds_write_addtid_b32 v28 offset:12000
    ds_write_addtid_b32 v29 offset:12256
    ds_write_addtid_b32 v30 offset:12512
    ds_read_b128 v[128:131], v5 offset:0
    ds_read_b128 v[132:135], v5 offset:64
    ds_read_b128 v[136:139], v5 offset:128
    ds_read_b128 v[140:143], v5 offset:192
    ds_read_b128 v[144:147], v5 offset:256
    ds_read_b128 v[148:151], v5 offset:320
    ds_read_b128 v[152:155], v5 offset:384
    ds_read_b128 v[156:159], v5 offset:448
    ds_read_b128 v[160:163], v5 offset:512
    ds_read_b128 v[164:167], v5 offset:576
    ds_read_b128 v[168:171], v5 offset:640
    ds_read_b128 v[172:175], v5 offset:704
    v_mul_f32 v58, v112, v112
    v_mul_f32 v60, v114, v114
    v_mul_f32 v62, v116, v116
    v_mul_f32 v59, v112, v113
    v_mul_f32 v61, v114, v115
    v_mul_f32 v63, v116, v117
    v_fma_f32 v58, -v113, v113, v58
    v_fma_f32 v60, -v115, v115, v60
    v_fma_f32 v62, -v117, v117, v62
    v_fmac_f32 v59, v113, v112
    v_fmac_f32 v61, v115, v114
    v_fmac_f32 v63, v117, v116
    v_mul_f32 v64, v118, v118
    v_mul_f32 v66, v120, v120
    v_mul_f32 v68, v122, v122
    v_mul_f32 v65, v118, v119
    v_mul_f32 v67, v120, v121
    v_mul_f32 v69, v122, v123
    v_fma_f32 v64, -v119, v119, v64
    v_fma_f32 v66, -v121, v121, v66
    v_fma_f32 v68, -v123, v123, v68
    v_fmac_f32 v65, v119, v118
    v_fmac_f32 v67, v121, v120
    v_fmac_f32 v69, v123, v122
    v_mul_f32 v70, v58, v106
    v_mul_f32 v72, v60, v108
    v_mul_f32 v74, v62, v110
    s_waitcnt lgkmcnt(0)
    v_mfma_f32_16x16x32_bf16 v[228:231], v[128:131], v[176:179], 0
    v_mul_f32 v71, v58, v107
    v_mul_f32 v73, v60, v109
    v_mul_f32 v75, v62, v111
    v_fma_f32 v70, -v59, v107, v70
    v_fma_f32 v72, -v61, v109, v72
    v_mfma_f32_16x16x32_bf16 v[228:231], v[132:135], v[180:183], v[228:231]
    v_fma_f32 v74, -v63, v111, v74
    v_fmac_f32 v71, v59, v106
    v_fmac_f32 v73, v61, v108
    v_fmac_f32 v75, v63, v110
    v_mul_f32 v82, v64, v106
    v_mfma_f32_16x16x32_bf16 v[228:231], v[136:139], v[184:187], v[228:231]
    v_mul_f32 v84, v66, v108
    v_mul_f32 v86, v68, v110
    v_mul_f32 v83, v64, v107
    v_mul_f32 v85, v66, v109
    v_mul_f32 v87, v68, v111
    v_mfma_f32_16x16x32_bf16 v[228:231], v[140:143], v[188:191], v[228:231]
    v_fma_f32 v82, -v65, v107, v82
    v_fma_f32 v84, -v67, v109, v84
    v_fma_f32 v86, -v69, v111, v86
    v_fmac_f32 v83, v65, v106
    v_fmac_f32 v85, v67, v108
    v_mfma_f32_16x16x32_bf16 v[228:231], v[144:147], v[192:195], v[228:231]
    v_fmac_f32 v87, v69, v110
    v_cvt_pk_bf16_f32 v28, v58, v59
    v_cvt_pk_bf16_f32 v29, v60, v61
    v_cvt_pk_bf16_f32 v30, v62, v63
    ds_write_addtid_b32 v28 offset:0
    v_mfma_f32_16x16x32_bf16 v[228:231], v[148:151], v[196:199], v[228:231]
    ds_write_addtid_b32 v29 offset:256
    ds_write_addtid_b32 v30 offset:512
    v_mul_f32 v94, v58, v76
    v_mul_f32 v96, v60, v78
    v_mul_f32 v98, v62, v80
    v_mfma_f32_16x16x32_bf16 v[228:231], v[152:155], v[200:203], v[228:231]
    v_mul_f32 v95, v58, v77
    v_mul_f32 v97, v60, v79
    v_mul_f32 v99, v62, v81
    v_fma_f32 v94, -v59, v77, v94
    v_fma_f32 v96, -v61, v79, v96
    v_mfma_f32_16x16x32_bf16 v[228:231], v[156:159], v[204:207], v[228:231]
    v_fma_f32 v98, -v63, v81, v98
    v_fmac_f32 v95, v59, v76
    v_fmac_f32 v97, v61, v78
    v_fmac_f32 v99, v63, v80
    v_cvt_pk_bf16_f32 v28, v94, v95
    v_mfma_f32_16x16x32_bf16 v[228:231], v[160:163], v[208:211], v[228:231]
    v_cvt_pk_bf16_f32 v29, v96, v97
    v_cvt_pk_bf16_f32 v30, v98, v99
    ds_write_addtid_b32 v28 offset:800
    ds_write_addtid_b32 v29 offset:1056
    ds_write_addtid_b32 v30 offset:1312
    v_mfma_f32_16x16x32_bf16 v[228:231], v[164:167], v[212:215], v[228:231]
    v_cvt_pk_bf16_f32 v28, v70, v71
    v_cvt_pk_bf16_f32 v29, v72, v73
    v_cvt_pk_bf16_f32 v30, v74, v75
    ds_write_addtid_b32 v28 offset:3200
    ds_write_addtid_b32 v29 offset:3456
    v_mfma_f32_16x16x32_bf16 v[228:231], v[168:171], v[216:219], v[228:231]
    ds_write_addtid_b32 v30 offset:3712
    v_mul_f32 v94, v70, v76
    v_mul_f32 v96, v72, v78
    v_mul_f32 v98, v74, v80
    v_mul_f32 v95, v70, v77
    v_mfma_f32_16x16x32_bf16 v[228:231], v[172:175], v[220:223], v[228:231]
    v_mul_f32 v97, v72, v79
    v_mul_f32 v99, v74, v81
    v_fma_f32 v94, -v71, v77, v94
    v_fma_f32 v96, -v73, v79, v96
    v_fma_f32 v98, -v75, v81, v98
    v_fmac_f32 v95, v71, v76
    v_fmac_f32 v97, v73, v78
    v_fmac_f32 v99, v75, v80
    v_cvt_pk_bf16_f32 v28, v94, v95
    v_cvt_pk_bf16_f32 v29, v96, v97
    v_cvt_pk_bf16_f32 v30, v98, v99
    ds_write_addtid_b32 v28 offset:4000
    ds_write_addtid_b32 v29 offset:4256
    ds_write_addtid_b32 v30 offset:4512
    v_cvt_pk_bf16_f32 v28, v64, v65
    v_cvt_pk_bf16_f32 v29, v66, v67
    v_cvt_pk_bf16_f32 v30, v68, v69
    ds_write_addtid_b32 v28 offset:6400
    ds_write_addtid_b32 v29 offset:6656
    ds_write_addtid_b32 v30 offset:6912
    v_mul_f32 v94, v64, v76
    v_mul_f32 v96, v66, v78
    v_mul_f32 v98, v68, v80
    v_mul_f32 v95, v64, v77
    v_mul_f32 v97, v66, v79
    v_mul_f32 v99, v68, v81
    v_fma_f32 v94, -v65, v77, v94
    v_fma_f32 v96, -v67, v79, v96
    v_fma_f32 v98, -v69, v81, v98
    v_fmac_f32 v95, v65, v76
    v_fmac_f32 v97, v67, v78
    v_fmac_f32 v99, v69, v80
    v_cvt_pk_bf16_f32 v28, v94, v95
    v_cvt_pk_bf16_f32 v29, v96, v97
    v_cvt_pk_bf16_f32 v30, v98, v99
    ds_write_addtid_b32 v28 offset:7200
    ds_write_addtid_b32 v29 offset:7456
    ds_write_addtid_b32 v30 offset:7712
    v_cvt_pk_bf16_f32 v28, v82, v83
    v_cvt_pk_bf16_f32 v29, v84, v85
    v_cvt_pk_bf16_f32 v30, v86, v87
    ds_write_addtid_b32 v28 offset:9600
    ds_write_addtid_b32 v29 offset:9856
    ds_write_addtid_b32 v30 offset:10112
    v_mul_f32 v94, v82, v76
    v_mul_f32 v96, v84, v78
    v_mul_f32 v98, v86, v80
    v_mul_f32 v95, v82, v77
    v_mul_f32 v97, v84, v79
    v_mul_f32 v99, v86, v81
    v_fma_f32 v94, -v83, v77, v94
    v_fma_f32 v96, -v85, v79, v96
    v_fma_f32 v98, -v87, v81, v98
    v_fmac_f32 v95, v83, v76
    v_fmac_f32 v97, v85, v78
    v_fmac_f32 v99, v87, v80
    v_cvt_pk_bf16_f32 v28, v94, v95
    v_cvt_pk_bf16_f32 v29, v96, v97
    v_cvt_pk_bf16_f32 v30, v98, v99
    ds_write_addtid_b32 v28 offset:10400
    ds_write_addtid_b32 v29 offset:10656
    ds_write_addtid_b32 v30 offset:10912
    v_mul_f32 v100, v94, v76
    v_mul_f32 v102, v96, v78
    v_mul_f32 v104, v98, v80
    v_mul_f32 v101, v94, v77
    v_mul_f32 v103, v96, v79
    v_mul_f32 v105, v98, v81
    v_fma_f32 v100, -v95, v77, v100
    v_fma_f32 v102, -v97, v79, v102
    v_fma_f32 v104, -v99, v81, v104
    v_fmac_f32 v101, v95, v76
    v_fmac_f32 v103, v97, v78
    v_fmac_f32 v105, v99, v80
    v_cvt_pk_bf16_f32 v28, v100, v101
    v_cvt_pk_bf16_f32 v29, v102, v103
    v_cvt_pk_bf16_f32 v30, v104, v105
    ds_write_addtid_b32 v28 offset:11200
    ds_write_addtid_b32 v29 offset:11456
    ds_write_addtid_b32 v30 offset:11712
    ds_read_b128 v[128:131], v5 offset:0
    ds_read_b128 v[132:135], v5 offset:64
    ds_read_b128 v[136:139], v5 offset:128
    ds_read_b128 v[140:143], v5 offset:192
    ds_read_b128 v[144:147], v5 offset:256
    ds_read_b128 v[148:151], v5 offset:320
    ds_read_b128 v[152:155], v5 offset:384
    ds_read_b128 v[156:159], v5 offset:448
    ds_read_b128 v[160:163], v5 offset:512
    ds_read_b128 v[164:167], v5 offset:576
    ds_read_b128 v[168:171], v5 offset:640
    ds_read_b128 v[172:175], v5 offset:704
    s_add_u32 s9, s8, 4160
    v_and_b32 v6, 15, v1
    v_lshrrev_b32 v7, 4, v1
    v_lshl_add_u32 v6, v6, 5, s9
    v_lshl_add_u32 v2, v7, 3, v6
    v_lshl_add_u32 v4, v7, 4, v6
    v_lshl_add_u32 v5, v7, 9, v6
    v_min_u32 v6, 29, v1
    v_lshl_add_u32 v6, v6, 4, s9
    v_mov_b32 v28, 0
    v_mov_b32 v29, 0
    v_mov_b32 v30, 0
    v_mov_b32 v31, 0
    v_cvt_pk_bf16_f32 v32, v224, v225
    v_cvt_pk_bf16_f32 v33, v226, v227
    s_waitcnt lgkmcnt(0)
    s_barrier
    s_waitcnt lgkmcnt(0)
    v_mfma_f32_16x16x32_bf16 v[232:235], v[128:131], v[176:179], 0
    ds_write_b128 v6, v[28:31]
    v_mfma_f32_16x16x32_bf16 v[232:235], v[132:135], v[180:183], v[232:235]
    ds_write_b64 v2, v[32:33] offset:480
    v_mfma_f32_16x16x32_bf16 v[232:235], v[136:139], v[184:187], v[232:235]
    v_mov_b32_dpp v56, v228 wave_shl:1 row_mask:0xf bank_mask:0xf
    v_mfma_f32_16x16x32_bf16 v[232:235], v[140:143], v[188:191], v[232:235]
    v_mov_b32 v57, v228
    v_mfma_f32_16x16x32_bf16 v[232:235], v[144:147], v[192:195], v[232:235]
    s_mov_b64 s[10:11], 0xffff
    v_mfma_f32_16x16x32_bf16 v[232:235], v[148:151], v[196:199], v[232:235]
    v_mov_b32 v58, v56
    v_mfma_f32_16x16x32_bf16 v[232:235], v[152:155], v[200:203], v[232:235]
    s_mov_b32 s14, 0x7fff0000
    v_mfma_f32_16x16x32_bf16 v[232:235], v[156:159], v[204:207], v[232:235]
    s_mov_b32 s15, 0
    v_mfma_f32_16x16x32_bf16 v[232:235], v[160:163], v[208:211], v[232:235]
    v_permlane16_swap_b32 v57, v58
    v_mfma_f32_16x16x32_bf16 v[232:235], v[164:167], v[212:215], v[232:235]
    s_nop 0
    v_mfma_f32_16x16x32_bf16 v[232:235], v[168:171], v[216:219], v[232:235]
    v_cndmask_b32 v59, v56, v58, s[10:11]
    v_mfma_f32_16x16x32_bf16 v[232:235], v[172:175], v[220:223], v[232:235]
    v_cndmask_b32 v59, v59, v57, s[14:15]
    v_cvt_pk_bf16_f32 v44, v228, v228
    v_cvt_pk_bf16_f32 v45, v229, v230
    v_cvt_pk_bf16_f32 v46, v230, v230
    v_cvt_pk_bf16_f32 v47, v231, v59
    v_cvt_pk_bf16_f32 v48, v228, v228
    v_cvt_pk_bf16_f32 v49, v228, v229
    v_cvt_pk_bf16_f32 v50, v229, v229
    v_cvt_pk_bf16_f32 v51, v230, v230
    v_cvt_pk_bf16_f32 v52, v230, v230
    v_cvt_pk_bf16_f32 v53, v230, v231
    v_cvt_pk_bf16_f32 v54, v231, v231
    s_mov_b32 exec_hi, 0
    ds_write_b128 v4, v[44:47] offset:992
    s_mov_b64 exec, -1
    v_readlane_b32 s10, v232, 0
    v_mov_b32 v60, v234
    s_nop 2
    v_writelane_b32 v59, s10, 63
    v_mov_b32_dpp v60, v232 wave_shl:1 row_mask:0xf bank_mask:0xf
    v_cvt_pk_bf16_f32 v55, v59, v59
    v_cvt_pk_bf16_f32 v36, v232, v232
    v_cvt_pk_bf16_f32 v37, v232, v232
    v_cvt_pk_bf16_f32 v38, v232, v233
    v_cvt_pk_bf16_f32 v39, v233, v233
    v_cvt_pk_bf16_f32 v40, v233, v233
    v_cvt_pk_bf16_f32 v41, v233, v233
    v_cvt_pk_bf16_f32 v42, v60, v60
    v_cvt_pk_bf16_f32 v43, v60, v60
    ds_write_b128 v5, v[36:39] offset:2528
    ds_write_b128 v5, v[40:43] offset:2544
    s_mov_b32 exec_lo, 0
    ds_write_b128 v5, v[48:51] offset:480
    ds_write_b128 v5, v[52:55] offset:496
    s_mov_b64 exec, -1
    s_mul_i32 s13, s3, 12768
    s_mul_i32 s14, s3, 12480
    s_add_u32 s14, s14, 38304
    v_bfe_u32 v6, v1, 2, 2
    v_mul_u32_u24 v7, 4160, v6
    v_add_u32 v7, s14, v7
    v_mov_b32 v3, s13
    v_cmp_eq_u32 vcc, 3, v6
    v_and_b32 v6, 3, v1
    s_nop 0
    v_cndmask_b32 v3, v7, v3, vcc
    v_lshl_add_u32 v3, v6, 3, v3
    v_lshrrev_b32 v7, 4, v1
    v_lshlrev_b32 v7, 4, v7
    v_sub_u32 v3, v3, v7
    v_add_u32 v3, 32, v3
    v_and_b32 v6, 15, v1
    v_lshl_add_u32 v4, v6, 5, v7
    s_add_u32 s13, s13, 4160
    v_add_u32 v4, s13, v4
    s_mul_i32 s14, s3, 12480
    s_add_u32 s14, s14, 38336
    v_and_b32 v6, 15, v1
    v_lshrrev_b32 v7, 4, v1
    v_lshl_add_u32 v5, v6, 5, s14
    v_lshl_add_u32 v5, v7, 3, v5
    v_lshlrev_b32 v6, 5, v6
    v_lshrrev_b32 v7, 5, v1
    v_lshl_add_u32 v6, v7, 4, v6
    v_bfe_u32 v7, v1, 4, 1
    v_lshl_add_u32 v2, v7, 9, v6
    v_mul_u32_u24 v7, 1536, v7
    v_add_u32 v0, v7, v6
    s_mov_b32 s12, 0xffff0000
    s_lshl_b32 s9, s6, 12
    s_add_u32 s9, s9, 6291456
    s_waitcnt lgkmcnt(0)
    s_barrier
    s_setprio 2
    ds_read_b64 v[8:9], v5 offset:0
    ds_read_b64 v[10:11], v5 offset:512
    ds_read_b64 v[12:13], v5 offset:2048
    ds_read_b64 v[14:15], v5 offset:2560
    ds_read_b64 v[16:17], v5 offset:3072
    ds_read_b64 v[18:19], v5 offset:3584
    ds_read_b128 v[128:131], v4 offset:0
    ds_read_b64_tr_b16 v[64:65], v3 offset:480
    ds_read_b64_tr_b16 v[66:67], v3 offset:472
    ds_read_b128 v[132:135], v4 offset:512
    ds_read_b64_tr_b16 v[68:69], v3 offset:992
    ds_read_b64_tr_b16 v[70:71], v3 offset:984
    ds_read_b128 v[136:139], v4 offset:1024
    ds_read_b64_tr_b16 v[72:73], v3 offset:1504
    ds_read_b64_tr_b16 v[74:75], v3 offset:1496
    ds_read_b128 v[140:143], v4 offset:1536
    ds_read_b64_tr_b16 v[76:77], v3 offset:2016
    ds_read_b64_tr_b16 v[78:79], v3 offset:2008
    ds_read_b128 v[144:147], v4 offset:2048
    ds_read_b64_tr_b16 v[80:81], v3 offset:2528
    ds_read_b64_tr_b16 v[82:83], v3 offset:2520
    ds_read_b128 v[148:151], v4 offset:2560
    ds_read_b64_tr_b16 v[84:85], v3 offset:3040
    ds_read_b64_tr_b16 v[86:87], v3 offset:3032
    ds_read_b128 v[152:155], v4 offset:3072
    ds_read_b64_tr_b16 v[88:89], v3 offset:3552
    ds_read_b64_tr_b16 v[90:91], v3 offset:3544
    ds_read_b128 v[156:159], v4 offset:3584
    ds_read_b64_tr_b16 v[92:93], v3 offset:4064
    ds_read_b64_tr_b16 v[94:95], v3 offset:4056
    s_waitcnt lgkmcnt(0)
    v_mfma_f32_16x16x32_bf16 v[32:35], v[64:67], v[128:131], 0
    ds_read_b128 v[160:163], v4 offset:64
    v_mfma_f32_16x16x32_bf16 v[36:39], v[68:71], v[128:131], 0
    ds_read_b64_tr_b16 v[96:97], v3 offset:416
    v_mfma_f32_16x16x32_bf16 v[40:43], v[80:83], v[128:131], 0
    ds_read_b64_tr_b16 v[98:99], v3 offset:408
    v_mfma_f32_16x16x32_bf16 v[44:47], v[84:87], v[128:131], 0
    ds_read_b128 v[164:167], v4 offset:576
    v_mfma_f32_16x16x32_bf16 v[48:51], v[88:91], v[128:131], 0
    ds_read_b64_tr_b16 v[100:101], v3 offset:928
    v_mfma_f32_16x16x32_bf16 v[52:55], v[92:95], v[128:131], 0
    ds_read_b64_tr_b16 v[102:103], v3 offset:920
    v_mfma_f32_16x16x32_bf16 v[36:39], v[64:67], v[132:135], v[36:39]
    ds_read_b128 v[168:171], v4 offset:1088
    v_mfma_f32_16x16x32_bf16 v[40:43], v[76:79], v[132:135], v[40:43]
    ds_read_b64_tr_b16 v[104:105], v3 offset:1440
    v_mfma_f32_16x16x32_bf16 v[44:47], v[80:83], v[132:135], v[44:47]
    ds_read_b64_tr_b16 v[106:107], v3 offset:1432
    v_mfma_f32_16x16x32_bf16 v[48:51], v[84:87], v[132:135], v[48:51]
    ds_read_b128 v[172:175], v4 offset:1600
    v_mfma_f32_16x16x32_bf16 v[52:55], v[88:91], v[132:135], v[52:55]
    ds_read_b64_tr_b16 v[108:109], v3 offset:1952
    v_mfma_f32_16x16x32_bf16 v[40:43], v[72:75], v[136:139], v[40:43]
    ds_read_b64_tr_b16 v[110:111], v3 offset:1944
    v_mfma_f32_16x16x32_bf16 v[44:47], v[76:79], v[136:139], v[44:47]
    ds_read_b128 v[176:179], v4 offset:2112
    v_mfma_f32_16x16x32_bf16 v[48:51], v[80:83], v[136:139], v[48:51]
    ds_read_b64_tr_b16 v[112:113], v3 offset:2464
    v_mfma_f32_16x16x32_bf16 v[52:55], v[84:87], v[136:139], v[52:55]
    ds_read_b64_tr_b16 v[114:115], v3 offset:2456
    v_mfma_f32_16x16x32_bf16 v[40:43], v[68:71], v[140:143], v[40:43]
    ds_read_b128 v[180:183], v4 offset:2624
    v_mfma_f32_16x16x32_bf16 v[44:47], v[72:75], v[140:143], v[44:47]
    ds_read_b64_tr_b16 v[116:117], v3 offset:2976
    v_mfma_f32_16x16x32_bf16 v[48:51], v[76:79], v[140:143], v[48:51]
    ds_read_b64_tr_b16 v[118:119], v3 offset:2968
    v_mfma_f32_16x16x32_bf16 v[52:55], v[80:83], v[140:143], v[52:55]
    ds_read_b128 v[184:187], v4 offset:3136
    v_mfma_f32_16x16x32_bf16 v[40:43], v[64:67], v[144:147], v[40:43]
    ds_read_b64_tr_b16 v[120:121], v3 offset:3488
    v_mfma_f32_16x16x32_bf16 v[44:47], v[68:71], v[144:147], v[44:47]
    ds_read_b64_tr_b16 v[122:123], v3 offset:3480
    v_mfma_f32_16x16x32_bf16 v[48:51], v[72:75], v[144:147], v[48:51]
    ds_read_b128 v[188:191], v4 offset:3648
    v_mfma_f32_16x16x32_bf16 v[52:55], v[76:79], v[144:147], v[52:55]
    ds_read_b64_tr_b16 v[124:125], v3 offset:4000
    v_mfma_f32_16x16x32_bf16 v[44:47], v[64:67], v[148:151], v[44:47]
    ds_read_b64_tr_b16 v[126:127], v3 offset:3992
    v_mfma_f32_16x16x32_bf16 v[48:51], v[68:71], v[148:151], v[48:51]
    v_mfma_f32_16x16x32_bf16 v[52:55], v[72:75], v[148:151], v[52:55]
    v_mfma_f32_16x16x32_bf16 v[48:51], v[64:67], v[152:155], v[48:51]
    v_mfma_f32_16x16x32_bf16 v[52:55], v[68:71], v[152:155], v[52:55]
    v_mfma_f32_16x16x32_bf16 v[52:55], v[64:67], v[156:159], v[52:55]
    s_waitcnt lgkmcnt(0)
    v_mfma_f32_16x16x32_bf16 v[32:35], v[96:99], v[160:163], v[32:35]
    ds_read_b128 v[128:131], v4 offset:128
    v_lshlrev_b32 v196, 16, v8
    v_mfma_f32_16x16x32_bf16 v[36:39], v[100:103], v[160:163], v[36:39]
    ds_read_b64_tr_b16 v[64:65], v3 offset:352
    v_and_b32 v197, s12, v8
    v_mfma_f32_16x16x32_bf16 v[40:43], v[112:115], v[160:163], v[40:43]
    ds_read_b64_tr_b16 v[66:67], v3 offset:344
    v_lshlrev_b32 v198, 16, v9
    v_mfma_f32_16x16x32_bf16 v[44:47], v[116:119], v[160:163], v[44:47]
    ds_read_b128 v[132:135], v4 offset:640
    v_and_b32 v199, s12, v9
    v_mfma_f32_16x16x32_bf16 v[48:51], v[120:123], v[160:163], v[48:51]
    ds_read_b64_tr_b16 v[68:69], v3 offset:864
    v_mul_f32 v196, v27, v196
    v_mfma_f32_16x16x32_bf16 v[52:55], v[124:127], v[160:163], v[52:55]
    ds_read_b64_tr_b16 v[70:71], v3 offset:856
    v_mul_f32 v197, v27, v197
    v_mfma_f32_16x16x32_bf16 v[36:39], v[96:99], v[164:167], v[36:39]
    ds_read_b128 v[136:139], v4 offset:1152
    v_mul_f32 v198, v27, v198
    v_mfma_f32_16x16x32_bf16 v[40:43], v[108:111], v[164:167], v[40:43]
    ds_read_b64_tr_b16 v[72:73], v3 offset:1376
    v_mul_f32 v199, v27, v199
    v_mfma_f32_16x16x32_bf16 v[44:47], v[112:115], v[164:167], v[44:47]
    ds_read_b64_tr_b16 v[74:75], v3 offset:1368
    v_cvt_pk_bf16_f32 v196, 0, v196
    v_mfma_f32_16x16x32_bf16 v[48:51], v[116:119], v[164:167], v[48:51]
    ds_read_b128 v[140:143], v4 offset:1664
    v_cvt_pk_bf16_f32 v197, 0, v197
    v_mfma_f32_16x16x32_bf16 v[52:55], v[120:123], v[164:167], v[52:55]
    ds_read_b64_tr_b16 v[76:77], v3 offset:1888
    v_cvt_pk_bf16_f32 v198, 0, v198
    v_mfma_f32_16x16x32_bf16 v[40:43], v[104:107], v[168:171], v[40:43]
    ds_read_b64_tr_b16 v[78:79], v3 offset:1880
    v_cvt_pk_bf16_f32 v199, 0, v199
    v_mfma_f32_16x16x32_bf16 v[44:47], v[108:111], v[168:171], v[44:47]
    ds_read_b128 v[144:147], v4 offset:2176
    v_lshlrev_b32 v200, 16, v10
    v_mfma_f32_16x16x32_bf16 v[48:51], v[112:115], v[168:171], v[48:51]
    ds_read_b64_tr_b16 v[80:81], v3 offset:2400
    v_and_b32 v201, s12, v10
    v_mfma_f32_16x16x32_bf16 v[52:55], v[116:119], v[168:171], v[52:55]
    ds_read_b64_tr_b16 v[82:83], v3 offset:2392
    v_lshlrev_b32 v202, 16, v11
    v_mfma_f32_16x16x32_bf16 v[40:43], v[100:103], v[172:175], v[40:43]
    ds_read_b128 v[148:151], v4 offset:2688
    v_and_b32 v203, s12, v11
    v_mfma_f32_16x16x32_bf16 v[44:47], v[104:107], v[172:175], v[44:47]
    ds_read_b64_tr_b16 v[84:85], v3 offset:2912
    v_mul_f32 v200, v27, v200
    v_mfma_f32_16x16x32_bf16 v[48:51], v[108:111], v[172:175], v[48:51]
    ds_read_b64_tr_b16 v[86:87], v3 offset:2904
    v_mul_f32 v201, v27, v201
    v_mfma_f32_16x16x32_bf16 v[52:55], v[112:115], v[172:175], v[52:55]
    ds_read_b128 v[152:155], v4 offset:3200
    v_mul_f32 v202, v27, v202
    v_mfma_f32_16x16x32_bf16 v[40:43], v[96:99], v[176:179], v[40:43]
    ds_read_b64_tr_b16 v[88:89], v3 offset:3424
    v_mul_f32 v203, v27, v203
    v_mfma_f32_16x16x32_bf16 v[44:47], v[100:103], v[176:179], v[44:47]
    ds_read_b64_tr_b16 v[90:91], v3 offset:3416
    v_cvt_pk_bf16_f32 v200, 0, v200
    v_mfma_f32_16x16x32_bf16 v[48:51], v[104:107], v[176:179], v[48:51]
    ds_read_b128 v[156:159], v4 offset:3712
    v_cvt_pk_bf16_f32 v201, 0, v201
    v_mfma_f32_16x16x32_bf16 v[52:55], v[108:111], v[176:179], v[52:55]
    ds_read_b64_tr_b16 v[92:93], v3 offset:3936
    v_cvt_pk_bf16_f32 v202, 0, v202
    v_mfma_f32_16x16x32_bf16 v[44:47], v[96:99], v[180:183], v[44:47]
    ds_read_b64_tr_b16 v[94:95], v3 offset:3928
    v_cvt_pk_bf16_f32 v203, 0, v203
    v_mfma_f32_16x16x32_bf16 v[48:51], v[100:103], v[180:183], v[48:51]
    v_lshlrev_b32 v204, 16, v12
    v_mfma_f32_16x16x32_bf16 v[52:55], v[104:107], v[180:183], v[52:55]
    v_and_b32 v205, s12, v12
    v_mfma_f32_16x16x32_bf16 v[48:51], v[96:99], v[184:187], v[48:51]
    v_lshlrev_b32 v206, 16, v13
    v_mfma_f32_16x16x32_bf16 v[52:55], v[100:103], v[184:187], v[52:55]
    v_and_b32 v207, s12, v13
    v_mfma_f32_16x16x32_bf16 v[52:55], v[96:99], v[188:191], v[52:55]
    v_mul_f32 v204, v27, v204
    s_waitcnt lgkmcnt(0)
    v_mfma_f32_16x16x32_bf16 v[32:35], v[64:67], v[128:131], v[32:35]
    ds_read_b128 v[160:163], v4 offset:192
    v_mul_f32 v205, v27, v205
    v_mfma_f32_16x16x32_bf16 v[36:39], v[68:71], v[128:131], v[36:39]
    ds_read_b64_tr_b16 v[96:97], v3 offset:288
    v_mul_f32 v206, v27, v206
    v_mfma_f32_16x16x32_bf16 v[40:43], v[80:83], v[128:131], v[40:43]
    ds_read_b64_tr_b16 v[98:99], v3 offset:280
    v_mul_f32 v207, v27, v207
    v_mfma_f32_16x16x32_bf16 v[44:47], v[84:87], v[128:131], v[44:47]
    ds_read_b128 v[164:167], v4 offset:704
    v_cvt_pk_bf16_f32 v204, 0, v204
    v_mfma_f32_16x16x32_bf16 v[48:51], v[88:91], v[128:131], v[48:51]
    ds_read_b64_tr_b16 v[100:101], v3 offset:800
    v_cvt_pk_bf16_f32 v205, 0, v205
    v_mfma_f32_16x16x32_bf16 v[52:55], v[92:95], v[128:131], v[52:55]
    ds_read_b64_tr_b16 v[102:103], v3 offset:792
    v_cvt_pk_bf16_f32 v206, 0, v206
    v_mfma_f32_16x16x32_bf16 v[36:39], v[64:67], v[132:135], v[36:39]
    ds_read_b128 v[168:171], v4 offset:1216
    v_cvt_pk_bf16_f32 v207, 0, v207
    v_mfma_f32_16x16x32_bf16 v[40:43], v[76:79], v[132:135], v[40:43]
    ds_read_b64_tr_b16 v[104:105], v3 offset:1312
    v_lshlrev_b32 v208, 16, v14
    v_mfma_f32_16x16x32_bf16 v[44:47], v[80:83], v[132:135], v[44:47]
    ds_read_b64_tr_b16 v[106:107], v3 offset:1304
    v_and_b32 v209, s12, v14
    v_mfma_f32_16x16x32_bf16 v[48:51], v[84:87], v[132:135], v[48:51]
    ds_read_b128 v[172:175], v4 offset:1728
    v_lshlrev_b32 v210, 16, v15
    v_mfma_f32_16x16x32_bf16 v[52:55], v[88:91], v[132:135], v[52:55]
    ds_read_b64_tr_b16 v[108:109], v3 offset:1824
    v_and_b32 v211, s12, v15
    v_mfma_f32_16x16x32_bf16 v[40:43], v[72:75], v[136:139], v[40:43]
    ds_read_b64_tr_b16 v[110:111], v3 offset:1816
    v_mul_f32 v208, v27, v208
    v_mfma_f32_16x16x32_bf16 v[44:47], v[76:79], v[136:139], v[44:47]
    ds_read_b128 v[176:179], v4 offset:2240
    v_mul_f32 v209, v27, v209
    v_mfma_f32_16x16x32_bf16 v[48:51], v[80:83], v[136:139], v[48:51]
    ds_read_b64_tr_b16 v[112:113], v3 offset:2336
    v_mul_f32 v210, v27, v210
    v_mfma_f32_16x16x32_bf16 v[52:55], v[84:87], v[136:139], v[52:55]
    ds_read_b64_tr_b16 v[114:115], v3 offset:2328
    v_mul_f32 v211, v27, v211
    v_mfma_f32_16x16x32_bf16 v[40:43], v[68:71], v[140:143], v[40:43]
    ds_read_b128 v[180:183], v4 offset:2752
    v_cvt_pk_bf16_f32 v208, 0, v208
    v_mfma_f32_16x16x32_bf16 v[44:47], v[72:75], v[140:143], v[44:47]
    ds_read_b64_tr_b16 v[116:117], v3 offset:2848
    v_cvt_pk_bf16_f32 v209, 0, v209
    v_mfma_f32_16x16x32_bf16 v[48:51], v[76:79], v[140:143], v[48:51]
    ds_read_b64_tr_b16 v[118:119], v3 offset:2840
    v_cvt_pk_bf16_f32 v210, 0, v210
    v_mfma_f32_16x16x32_bf16 v[52:55], v[80:83], v[140:143], v[52:55]
    ds_read_b128 v[184:187], v4 offset:3264
    v_cvt_pk_bf16_f32 v211, 0, v211
    v_mfma_f32_16x16x32_bf16 v[40:43], v[64:67], v[144:147], v[40:43]
    ds_read_b64_tr_b16 v[120:121], v3 offset:3360
    v_lshlrev_b32 v212, 16, v16
    v_mfma_f32_16x16x32_bf16 v[44:47], v[68:71], v[144:147], v[44:47]
    ds_read_b64_tr_b16 v[122:123], v3 offset:3352
    v_and_b32 v213, s12, v16
    v_mfma_f32_16x16x32_bf16 v[48:51], v[72:75], v[144:147], v[48:51]
    ds_read_b128 v[188:191], v4 offset:3776
    v_lshlrev_b32 v214, 16, v17
    v_mfma_f32_16x16x32_bf16 v[52:55], v[76:79], v[144:147], v[52:55]
    ds_read_b64_tr_b16 v[124:125], v3 offset:3872
    v_and_b32 v215, s12, v17
    v_mfma_f32_16x16x32_bf16 v[44:47], v[64:67], v[148:151], v[44:47]
    ds_read_b64_tr_b16 v[126:127], v3 offset:3864
    v_mul_f32 v212, v27, v212
    v_mfma_f32_16x16x32_bf16 v[48:51], v[68:71], v[148:151], v[48:51]
    v_mul_f32 v213, v27, v213
    v_mfma_f32_16x16x32_bf16 v[52:55], v[72:75], v[148:151], v[52:55]
    v_mul_f32 v214, v27, v214
    v_mfma_f32_16x16x32_bf16 v[48:51], v[64:67], v[152:155], v[48:51]
    v_mul_f32 v215, v27, v215
    v_mfma_f32_16x16x32_bf16 v[52:55], v[68:71], v[152:155], v[52:55]
    v_cvt_pk_bf16_f32 v212, 0, v212
    v_mfma_f32_16x16x32_bf16 v[52:55], v[64:67], v[156:159], v[52:55]
    v_cvt_pk_bf16_f32 v213, 0, v213
    s_waitcnt lgkmcnt(0)
    v_mfma_f32_16x16x32_bf16 v[32:35], v[96:99], v[160:163], v[32:35]
    ds_read_b128 v[128:131], v4 offset:256
    v_cvt_pk_bf16_f32 v214, 0, v214
    v_mfma_f32_16x16x32_bf16 v[36:39], v[100:103], v[160:163], v[36:39]
    ds_read_b64_tr_b16 v[64:65], v3 offset:224
    v_cvt_pk_bf16_f32 v215, 0, v215
    v_mfma_f32_16x16x32_bf16 v[40:43], v[112:115], v[160:163], v[40:43]
    ds_read_b64_tr_b16 v[66:67], v3 offset:216
    v_lshlrev_b32 v216, 16, v18
    v_mfma_f32_16x16x32_bf16 v[44:47], v[116:119], v[160:163], v[44:47]
    ds_read_b128 v[132:135], v4 offset:768
    v_and_b32 v217, s12, v18
    v_mfma_f32_16x16x32_bf16 v[48:51], v[120:123], v[160:163], v[48:51]
    ds_read_b64_tr_b16 v[68:69], v3 offset:736
    v_lshlrev_b32 v218, 16, v19
    v_mfma_f32_16x16x32_bf16 v[52:55], v[124:127], v[160:163], v[52:55]
    ds_read_b64_tr_b16 v[70:71], v3 offset:728
    v_and_b32 v219, s12, v19
    v_mfma_f32_16x16x32_bf16 v[36:39], v[96:99], v[164:167], v[36:39]
    ds_read_b128 v[136:139], v4 offset:1280
    v_mul_f32 v216, v27, v216
    v_mfma_f32_16x16x32_bf16 v[40:43], v[108:111], v[164:167], v[40:43]
    ds_read_b64_tr_b16 v[72:73], v3 offset:1248
    v_mul_f32 v217, v27, v217
    v_mfma_f32_16x16x32_bf16 v[44:47], v[112:115], v[164:167], v[44:47]
    ds_read_b64_tr_b16 v[74:75], v3 offset:1240
    v_mul_f32 v218, v27, v218
    v_mfma_f32_16x16x32_bf16 v[48:51], v[116:119], v[164:167], v[48:51]
    ds_read_b128 v[140:143], v4 offset:1792
    v_mul_f32 v219, v27, v219
    v_mfma_f32_16x16x32_bf16 v[52:55], v[120:123], v[164:167], v[52:55]
    ds_read_b64_tr_b16 v[76:77], v3 offset:1760
    v_cvt_pk_bf16_f32 v216, 0, v216
    v_mfma_f32_16x16x32_bf16 v[40:43], v[104:107], v[168:171], v[40:43]
    ds_read_b64_tr_b16 v[78:79], v3 offset:1752
    v_cvt_pk_bf16_f32 v217, 0, v217
    v_mfma_f32_16x16x32_bf16 v[44:47], v[108:111], v[168:171], v[44:47]
    ds_read_b128 v[144:147], v4 offset:2304
    v_cvt_pk_bf16_f32 v218, 0, v218
    v_mfma_f32_16x16x32_bf16 v[48:51], v[112:115], v[168:171], v[48:51]
    ds_read_b64_tr_b16 v[80:81], v3 offset:2272
    v_cvt_pk_bf16_f32 v219, 0, v219
    v_mfma_f32_16x16x32_bf16 v[52:55], v[116:119], v[168:171], v[52:55]
    ds_read_b64_tr_b16 v[82:83], v3 offset:2264
    v_mfma_f32_16x16x32_bf16 v[40:43], v[100:103], v[172:175], v[40:43]
    ds_read_b128 v[148:151], v4 offset:2816
    v_mfma_f32_16x16x32_bf16 v[44:47], v[104:107], v[172:175], v[44:47]
    ds_read_b64_tr_b16 v[84:85], v3 offset:2784
    v_mfma_f32_16x16x32_bf16 v[48:51], v[108:111], v[172:175], v[48:51]
    ds_read_b64_tr_b16 v[86:87], v3 offset:2776
    v_mfma_f32_16x16x32_bf16 v[52:55], v[112:115], v[172:175], v[52:55]
    ds_read_b128 v[152:155], v4 offset:3328
    v_mfma_f32_16x16x32_bf16 v[40:43], v[96:99], v[176:179], v[40:43]
    ds_read_b64_tr_b16 v[88:89], v3 offset:3296
    v_mfma_f32_16x16x32_bf16 v[44:47], v[100:103], v[176:179], v[44:47]
    ds_read_b64_tr_b16 v[90:91], v3 offset:3288
    v_mfma_f32_16x16x32_bf16 v[48:51], v[104:107], v[176:179], v[48:51]
    ds_read_b128 v[156:159], v4 offset:3840
    v_mfma_f32_16x16x32_bf16 v[52:55], v[108:111], v[176:179], v[52:55]
    ds_read_b64_tr_b16 v[92:93], v3 offset:3808
    v_mfma_f32_16x16x32_bf16 v[44:47], v[96:99], v[180:183], v[44:47]
    ds_read_b64_tr_b16 v[94:95], v3 offset:3800
    v_mfma_f32_16x16x32_bf16 v[48:51], v[100:103], v[180:183], v[48:51]
    v_mfma_f32_16x16x32_bf16 v[52:55], v[104:107], v[180:183], v[52:55]
    v_mfma_f32_16x16x32_bf16 v[48:51], v[96:99], v[184:187], v[48:51]
    v_mfma_f32_16x16x32_bf16 v[52:55], v[100:103], v[184:187], v[52:55]
    v_mfma_f32_16x16x32_bf16 v[52:55], v[96:99], v[188:191], v[52:55]
    s_waitcnt lgkmcnt(0)
    v_mfma_f32_16x16x32_bf16 v[32:35], v[64:67], v[128:131], v[32:35]
    ds_read_b128 v[160:163], v4 offset:320
    v_mfma_f32_16x16x32_bf16 v[36:39], v[68:71], v[128:131], v[36:39]
    ds_read_b64_tr_b16 v[96:97], v3 offset:160
    v_mfma_f32_16x16x32_bf16 v[40:43], v[80:83], v[128:131], v[40:43]
    ds_read_b64_tr_b16 v[98:99], v3 offset:152
    v_mfma_f32_16x16x32_bf16 v[44:47], v[84:87], v[128:131], v[44:47]
    ds_read_b128 v[164:167], v4 offset:832
    v_mfma_f32_16x16x32_bf16 v[48:51], v[88:91], v[128:131], v[48:51]
    ds_read_b64_tr_b16 v[100:101], v3 offset:672
    v_mfma_f32_16x16x32_bf16 v[52:55], v[92:95], v[128:131], v[52:55]
    ds_read_b64_tr_b16 v[102:103], v3 offset:664
    v_mfma_f32_16x16x32_bf16 v[36:39], v[64:67], v[132:135], v[36:39]
    ds_read_b128 v[168:171], v4 offset:1344
    v_mfma_f32_16x16x32_bf16 v[40:43], v[76:79], v[132:135], v[40:43]
    ds_read_b64_tr_b16 v[104:105], v3 offset:1184
    v_mfma_f32_16x16x32_bf16 v[44:47], v[80:83], v[132:135], v[44:47]
    ds_read_b64_tr_b16 v[106:107], v3 offset:1176
    v_mfma_f32_16x16x32_bf16 v[48:51], v[84:87], v[132:135], v[48:51]
    ds_read_b128 v[172:175], v4 offset:1856
    v_mfma_f32_16x16x32_bf16 v[52:55], v[88:91], v[132:135], v[52:55]
    ds_read_b64_tr_b16 v[108:109], v3 offset:1696
    v_mfma_f32_16x16x32_bf16 v[40:43], v[72:75], v[136:139], v[40:43]
    ds_read_b64_tr_b16 v[110:111], v3 offset:1688
    v_mfma_f32_16x16x32_bf16 v[44:47], v[76:79], v[136:139], v[44:47]
    ds_read_b128 v[176:179], v4 offset:2368
    v_mfma_f32_16x16x32_bf16 v[48:51], v[80:83], v[136:139], v[48:51]
    ds_read_b64_tr_b16 v[112:113], v3 offset:2208
    v_mfma_f32_16x16x32_bf16 v[52:55], v[84:87], v[136:139], v[52:55]
    ds_read_b64_tr_b16 v[114:115], v3 offset:2200
    v_mfma_f32_16x16x32_bf16 v[40:43], v[68:71], v[140:143], v[40:43]
    ds_read_b128 v[180:183], v4 offset:2880
    v_mfma_f32_16x16x32_bf16 v[44:47], v[72:75], v[140:143], v[44:47]
    ds_read_b64_tr_b16 v[116:117], v3 offset:2720
    v_mfma_f32_16x16x32_bf16 v[48:51], v[76:79], v[140:143], v[48:51]
    ds_read_b64_tr_b16 v[118:119], v3 offset:2712
    v_mfma_f32_16x16x32_bf16 v[52:55], v[80:83], v[140:143], v[52:55]
    ds_read_b128 v[184:187], v4 offset:3392
    v_mfma_f32_16x16x32_bf16 v[40:43], v[64:67], v[144:147], v[40:43]
    ds_read_b64_tr_b16 v[120:121], v3 offset:3232
    v_mfma_f32_16x16x32_bf16 v[44:47], v[68:71], v[144:147], v[44:47]
    ds_read_b64_tr_b16 v[122:123], v3 offset:3224
    v_mfma_f32_16x16x32_bf16 v[48:51], v[72:75], v[144:147], v[48:51]
    ds_read_b128 v[188:191], v4 offset:3904
    v_mfma_f32_16x16x32_bf16 v[52:55], v[76:79], v[144:147], v[52:55]
    ds_read_b64_tr_b16 v[124:125], v3 offset:3744
    v_mfma_f32_16x16x32_bf16 v[44:47], v[64:67], v[148:151], v[44:47]
    ds_read_b64_tr_b16 v[126:127], v3 offset:3736
    v_mfma_f32_16x16x32_bf16 v[48:51], v[68:71], v[148:151], v[48:51]
    v_mfma_f32_16x16x32_bf16 v[52:55], v[72:75], v[148:151], v[52:55]
    v_mfma_f32_16x16x32_bf16 v[48:51], v[64:67], v[152:155], v[48:51]
    v_mfma_f32_16x16x32_bf16 v[52:55], v[68:71], v[152:155], v[52:55]
    v_mfma_f32_16x16x32_bf16 v[52:55], v[64:67], v[156:159], v[52:55]
    s_waitcnt lgkmcnt(0)
    v_mfma_f32_16x16x32_bf16 v[32:35], v[96:99], v[160:163], v[32:35]
    ds_read_b128 v[128:131], v4 offset:384
    v_mfma_f32_16x16x32_bf16 v[36:39], v[100:103], v[160:163], v[36:39]
    ds_read_b64_tr_b16 v[64:65], v3 offset:96
    v_mfma_f32_16x16x32_bf16 v[40:43], v[112:115], v[160:163], v[40:43]
    ds_read_b64_tr_b16 v[66:67], v3 offset:88
    v_mfma_f32_16x16x32_bf16 v[44:47], v[116:119], v[160:163], v[44:47]
    ds_read_b128 v[132:135], v4 offset:896
    v_mfma_f32_16x16x32_bf16 v[48:51], v[120:123], v[160:163], v[48:51]
    ds_read_b64_tr_b16 v[68:69], v3 offset:608
    v_mfma_f32_16x16x32_bf16 v[52:55], v[124:127], v[160:163], v[52:55]
    ds_read_b64_tr_b16 v[70:71], v3 offset:600
    v_mfma_f32_16x16x32_bf16 v[36:39], v[96:99], v[164:167], v[36:39]
    ds_read_b128 v[136:139], v4 offset:1408
    v_mfma_f32_16x16x32_bf16 v[40:43], v[108:111], v[164:167], v[40:43]
    ds_read_b64_tr_b16 v[72:73], v3 offset:1120
    v_mfma_f32_16x16x32_bf16 v[44:47], v[112:115], v[164:167], v[44:47]
    ds_read_b64_tr_b16 v[74:75], v3 offset:1112
    v_mfma_f32_16x16x32_bf16 v[48:51], v[116:119], v[164:167], v[48:51]
    ds_read_b128 v[140:143], v4 offset:1920
    v_mfma_f32_16x16x32_bf16 v[52:55], v[120:123], v[164:167], v[52:55]
    ds_read_b64_tr_b16 v[76:77], v3 offset:1632
    v_mfma_f32_16x16x32_bf16 v[40:43], v[104:107], v[168:171], v[40:43]
    ds_read_b64_tr_b16 v[78:79], v3 offset:1624
    v_mfma_f32_16x16x32_bf16 v[44:47], v[108:111], v[168:171], v[44:47]
    ds_read_b128 v[144:147], v4 offset:2432
    v_mfma_f32_16x16x32_bf16 v[48:51], v[112:115], v[168:171], v[48:51]
    ds_read_b64_tr_b16 v[80:81], v3 offset:2144
    v_mfma_f32_16x16x32_bf16 v[52:55], v[116:119], v[168:171], v[52:55]
    ds_read_b64_tr_b16 v[82:83], v3 offset:2136
    v_mfma_f32_16x16x32_bf16 v[40:43], v[100:103], v[172:175], v[40:43]
    ds_read_b128 v[148:151], v4 offset:2944
    v_mfma_f32_16x16x32_bf16 v[44:47], v[104:107], v[172:175], v[44:47]
    ds_read_b64_tr_b16 v[84:85], v3 offset:2656
    v_mfma_f32_16x16x32_bf16 v[48:51], v[108:111], v[172:175], v[48:51]
    ds_read_b64_tr_b16 v[86:87], v3 offset:2648
    v_mfma_f32_16x16x32_bf16 v[52:55], v[112:115], v[172:175], v[52:55]
    ds_read_b128 v[152:155], v4 offset:3456
    v_mfma_f32_16x16x32_bf16 v[40:43], v[96:99], v[176:179], v[40:43]
    ds_read_b64_tr_b16 v[88:89], v3 offset:3168
    v_mfma_f32_16x16x32_bf16 v[44:47], v[100:103], v[176:179], v[44:47]
    ds_read_b64_tr_b16 v[90:91], v3 offset:3160
    v_mfma_f32_16x16x32_bf16 v[48:51], v[104:107], v[176:179], v[48:51]
    ds_read_b128 v[156:159], v4 offset:3968
    v_mfma_f32_16x16x32_bf16 v[52:55], v[108:111], v[176:179], v[52:55]
    ds_read_b64_tr_b16 v[92:93], v3 offset:3680
    v_mfma_f32_16x16x32_bf16 v[44:47], v[96:99], v[180:183], v[44:47]
    ds_read_b64_tr_b16 v[94:95], v3 offset:3672
    v_mfma_f32_16x16x32_bf16 v[48:51], v[100:103], v[180:183], v[48:51]
    v_mfma_f32_16x16x32_bf16 v[52:55], v[104:107], v[180:183], v[52:55]
    v_mfma_f32_16x16x32_bf16 v[48:51], v[96:99], v[184:187], v[48:51]
    v_mfma_f32_16x16x32_bf16 v[52:55], v[100:103], v[184:187], v[52:55]
    v_mfma_f32_16x16x32_bf16 v[52:55], v[96:99], v[188:191], v[52:55]
    s_waitcnt lgkmcnt(0)
    v_mfma_f32_16x16x32_bf16 v[32:35], v[64:67], v[128:131], v[32:35]
    ds_read_b128 v[160:163], v4 offset:448
    v_mfma_f32_16x16x32_bf16 v[36:39], v[68:71], v[128:131], v[36:39]
    ds_read_b64_tr_b16 v[96:97], v3 offset:32
    v_mfma_f32_16x16x32_bf16 v[40:43], v[80:83], v[128:131], v[40:43]
    ds_read_b64_tr_b16 v[98:99], v3 offset:24
    v_mfma_f32_16x16x32_bf16 v[44:47], v[84:87], v[128:131], v[44:47]
    ds_read_b128 v[164:167], v4 offset:960
    v_mfma_f32_16x16x32_bf16 v[48:51], v[88:91], v[128:131], v[48:51]
    ds_read_b64_tr_b16 v[100:101], v3 offset:544
    v_mfma_f32_16x16x32_bf16 v[52:55], v[92:95], v[128:131], v[52:55]
    ds_read_b64_tr_b16 v[102:103], v3 offset:536
    v_mfma_f32_16x16x32_bf16 v[36:39], v[64:67], v[132:135], v[36:39]
    ds_read_b128 v[168:171], v4 offset:1472
    v_mfma_f32_16x16x32_bf16 v[40:43], v[76:79], v[132:135], v[40:43]
    ds_read_b64_tr_b16 v[104:105], v3 offset:1056
    v_mfma_f32_16x16x32_bf16 v[44:47], v[80:83], v[132:135], v[44:47]
    ds_read_b64_tr_b16 v[106:107], v3 offset:1048
    v_mfma_f32_16x16x32_bf16 v[48:51], v[84:87], v[132:135], v[48:51]
    ds_read_b128 v[172:175], v4 offset:1984
    v_mfma_f32_16x16x32_bf16 v[52:55], v[88:91], v[132:135], v[52:55]
    ds_read_b64_tr_b16 v[108:109], v3 offset:1568
    v_mfma_f32_16x16x32_bf16 v[40:43], v[72:75], v[136:139], v[40:43]
    ds_read_b64_tr_b16 v[110:111], v3 offset:1560
    v_mfma_f32_16x16x32_bf16 v[44:47], v[76:79], v[136:139], v[44:47]
    ds_read_b128 v[176:179], v4 offset:2496
    v_mfma_f32_16x16x32_bf16 v[48:51], v[80:83], v[136:139], v[48:51]
    ds_read_b64_tr_b16 v[112:113], v3 offset:2080
    v_mfma_f32_16x16x32_bf16 v[52:55], v[84:87], v[136:139], v[52:55]
    ds_read_b64_tr_b16 v[114:115], v3 offset:2072
    v_mfma_f32_16x16x32_bf16 v[40:43], v[68:71], v[140:143], v[40:43]
    ds_read_b128 v[180:183], v4 offset:3008
    v_mfma_f32_16x16x32_bf16 v[44:47], v[72:75], v[140:143], v[44:47]
    ds_read_b64_tr_b16 v[116:117], v3 offset:2592
    v_mfma_f32_16x16x32_bf16 v[48:51], v[76:79], v[140:143], v[48:51]
    ds_read_b64_tr_b16 v[118:119], v3 offset:2584
    v_mfma_f32_16x16x32_bf16 v[52:55], v[80:83], v[140:143], v[52:55]
    ds_read_b128 v[184:187], v4 offset:3520
    v_mfma_f32_16x16x32_bf16 v[40:43], v[64:67], v[144:147], v[40:43]
    ds_read_b64_tr_b16 v[120:121], v3 offset:3104
    v_mfma_f32_16x16x32_bf16 v[44:47], v[68:71], v[144:147], v[44:47]
    ds_read_b64_tr_b16 v[122:123], v3 offset:3096
    v_mfma_f32_16x16x32_bf16 v[48:51], v[72:75], v[144:147], v[48:51]
    ds_read_b128 v[188:191], v4 offset:4032
    v_mfma_f32_16x16x32_bf16 v[52:55], v[76:79], v[144:147], v[52:55]
    ds_read_b64_tr_b16 v[124:125], v3 offset:3616
    v_mfma_f32_16x16x32_bf16 v[44:47], v[64:67], v[148:151], v[44:47]
    ds_read_b64_tr_b16 v[126:127], v3 offset:3608
    v_mfma_f32_16x16x32_bf16 v[48:51], v[68:71], v[148:151], v[48:51]
    v_mfma_f32_16x16x32_bf16 v[52:55], v[72:75], v[148:151], v[52:55]
    v_mfma_f32_16x16x32_bf16 v[48:51], v[64:67], v[152:155], v[48:51]
    v_mfma_f32_16x16x32_bf16 v[52:55], v[68:71], v[152:155], v[52:55]
    v_mfma_f32_16x16x32_bf16 v[52:55], v[64:67], v[156:159], v[52:55]
    s_waitcnt lgkmcnt(0)
    v_mfma_f32_16x16x32_bf16 v[32:35], v[96:99], v[160:163], v[32:35]
    v_mfma_f32_16x16x32_bf16 v[36:39], v[100:103], v[160:163], v[36:39]
    v_mfma_f32_16x16x32_bf16 v[40:43], v[112:115], v[160:163], v[40:43]
    v_mfma_f32_16x16x32_bf16 v[44:47], v[116:119], v[160:163], v[44:47]
    v_mfma_f32_16x16x32_bf16 v[48:51], v[120:123], v[160:163], v[48:51]
    v_mfma_f32_16x16x32_bf16 v[52:55], v[124:127], v[160:163], v[52:55]
    v_mfma_f32_16x16x32_bf16 v[36:39], v[96:99], v[164:167], v[36:39]
    v_mfma_f32_16x16x32_bf16 v[40:43], v[108:111], v[164:167], v[40:43]
    v_mfma_f32_16x16x32_bf16 v[44:47], v[112:115], v[164:167], v[44:47]
    v_mfma_f32_16x16x32_bf16 v[48:51], v[116:119], v[164:167], v[48:51]
    v_mfma_f32_16x16x32_bf16 v[52:55], v[120:123], v[164:167], v[52:55]
    v_mfma_f32_16x16x32_bf16 v[40:43], v[104:107], v[168:171], v[40:43]
    v_mfma_f32_16x16x32_bf16 v[44:47], v[108:111], v[168:171], v[44:47]
    v_mfma_f32_16x16x32_bf16 v[48:51], v[112:115], v[168:171], v[48:51]
    v_mfma_f32_16x16x32_bf16 v[52:55], v[116:119], v[168:171], v[52:55]
    v_mfma_f32_16x16x32_bf16 v[40:43], v[100:103], v[172:175], v[40:43]
    v_mfma_f32_16x16x32_bf16 v[44:47], v[104:107], v[172:175], v[44:47]
    v_mfma_f32_16x16x32_bf16 v[48:51], v[108:111], v[172:175], v[48:51]
    v_mfma_f32_16x16x32_bf16 v[52:55], v[112:115], v[172:175], v[52:55]
    v_mfma_f32_16x16x32_bf16 v[40:43], v[96:99], v[176:179], v[40:43]
    v_mfma_f32_16x16x32_bf16 v[44:47], v[100:103], v[176:179], v[44:47]
    v_mfma_f32_16x16x32_bf16 v[48:51], v[104:107], v[176:179], v[48:51]
    v_mfma_f32_16x16x32_bf16 v[52:55], v[108:111], v[176:179], v[52:55]
    v_mfma_f32_16x16x32_bf16 v[44:47], v[96:99], v[180:183], v[44:47]
    v_mfma_f32_16x16x32_bf16 v[48:51], v[100:103], v[180:183], v[48:51]
    v_mfma_f32_16x16x32_bf16 v[52:55], v[104:107], v[180:183], v[52:55]
    v_mfma_f32_16x16x32_bf16 v[48:51], v[96:99], v[184:187], v[48:51]
    v_mfma_f32_16x16x32_bf16 v[52:55], v[100:103], v[184:187], v[52:55]
    v_mfma_f32_16x16x32_bf16 v[52:55], v[96:99], v[188:191], v[52:55]
    v_cvt_pk_bf16_f32 v32, 0, v32
    v_cvt_pk_bf16_f32 v33, 0, v33
    v_cvt_pk_bf16_f32 v34, 0, v34
    v_cvt_pk_bf16_f32 v35, 0, v35
    v_add_f32 v32, v32, v196
    v_add_f32 v33, v33, v197
    v_add_f32 v34, v34, v198
    v_add_f32 v35, v35, v199
    v_cvt_pk_bf16_f32 v64, v32, v33
    v_cvt_pk_bf16_f32 v65, v34, v35
    v_cvt_pk_bf16_f32 v36, 0, v36
    v_cvt_pk_bf16_f32 v37, 0, v37
    v_cvt_pk_bf16_f32 v38, 0, v38
    v_cvt_pk_bf16_f32 v39, 0, v39
    v_add_f32 v36, v36, v200
    v_add_f32 v37, v37, v201
    v_add_f32 v38, v38, v202
    v_add_f32 v39, v39, v203
    v_cvt_pk_bf16_f32 v66, v36, v37
    v_cvt_pk_bf16_f32 v67, v38, v39
    s_nop 0
    v_permlane16_swap_b32 v64, v66
    v_permlane16_swap_b32 v65, v67
    buffer_store_dwordx4 v[64:67], v2, s[56:59], s9 offen offset:0 sc1
    v_cvt_pk_bf16_f32 v40, 0, v40
    v_cvt_pk_bf16_f32 v41, 0, v41
    v_cvt_pk_bf16_f32 v42, 0, v42
    v_cvt_pk_bf16_f32 v43, 0, v43
    v_add_f32 v40, v40, v204
    v_add_f32 v41, v41, v205
    v_add_f32 v42, v42, v206
    v_add_f32 v43, v43, v207
    v_cvt_pk_bf16_f32 v68, v40, v41
    v_cvt_pk_bf16_f32 v69, v42, v43
    v_cvt_pk_bf16_f32 v44, 0, v44
    v_cvt_pk_bf16_f32 v45, 0, v45
    v_cvt_pk_bf16_f32 v46, 0, v46
    v_cvt_pk_bf16_f32 v47, 0, v47
    v_add_f32 v44, v44, v208
    v_add_f32 v45, v45, v209
    v_add_f32 v46, v46, v210
    v_add_f32 v47, v47, v211
    v_cvt_pk_bf16_f32 v70, v44, v45
    v_cvt_pk_bf16_f32 v71, v46, v47
    s_nop 0
    v_permlane16_swap_b32 v68, v70
    v_permlane16_swap_b32 v69, v71
    buffer_store_dwordx4 v[68:71], v2, s[56:59], s9 offen offset:2048 sc1
    v_cvt_pk_bf16_f32 v48, 0, v48
    v_cvt_pk_bf16_f32 v49, 0, v49
    v_cvt_pk_bf16_f32 v50, 0, v50
    v_cvt_pk_bf16_f32 v51, 0, v51
    v_add_f32 v48, v48, v212
    v_add_f32 v49, v49, v213
    v_add_f32 v50, v50, v214
    v_add_f32 v51, v51, v215
    v_cvt_pk_bf16_f32 v72, v48, v49
    v_cvt_pk_bf16_f32 v73, v50, v51
    v_cvt_pk_bf16_f32 v52, 0, v52
    v_cvt_pk_bf16_f32 v53, 0, v53
    v_cvt_pk_bf16_f32 v54, 0, v54
    v_cvt_pk_bf16_f32 v55, 0, v55
    v_add_f32 v52, v52, v216
    v_add_f32 v53, v53, v217
    v_add_f32 v54, v54, v218
    v_add_f32 v55, v55, v219
    v_cvt_pk_bf16_f32 v74, v52, v53
    v_cvt_pk_bf16_f32 v75, v54, v55
    s_nop 0
    v_permlane16_swap_b32 v72, v74
    v_permlane16_swap_b32 v73, v75
    buffer_store_dwordx4 v[72:75], v2, s[56:59], s9 offen offset:3072 sc1
    s_lshl_b32 s9, s6, 2
    s_add_u32 s9, s9, 262144
    s_waitcnt vmcnt(0)
    v_mov_b32 v8, s4
    v_mul_u32_u24 v9, 2688, v1
    s_mov_b32 exec_lo, 0xffff00ff
    s_mov_b32 exec_hi, 0
    buffer_store_dword v8, v9, s[56:59], s9 offen sc1
    s_mov_b64 exec, -1
    s_endpgm
LW3:
    s_setprio 3
    s_and_b32 s8, s69, 7
    s_lshl_b32 s8, s8, 2
    s_lshr_b32 s9, s69, 3
    s_add_u32 s8, s8, s9
    s_mul_i32 s11, s8, 81920
    s_mul_i32 s12, s68, 160
    s_add_u32 s11, s11, s12
    s_add_u32 s12, s11, 5120
    s_mov_b32 s13, 1120
    s_mov_b32 s14, 5120
    v_add_u32 v2, 0, v1
    v_mul_u32_u24 v3, 6554, v2
    v_lshlrev_b32 v2, 4, v2
    v_lshrrev_b32 v3, 16, v3
    v_mad_u32_u24 v2, v3, s13, v2
    v_lshrrev_b32 v3, 2, v3
    v_mad_u32_u24 v16, v3, s14, v2
    v_add_u32 v2, 64, v1
    v_mul_u32_u24 v3, 6554, v2
    v_lshlrev_b32 v2, 4, v2
    v_lshrrev_b32 v3, 16, v3
    v_mad_u32_u24 v2, v3, s13, v2
    v_lshrrev_b32 v3, 2, v3
    v_mad_u32_u24 v17, v3, s14, v2
    v_add_u32 v2, 128, v1
    v_mul_u32_u24 v3, 6554, v2
    v_lshlrev_b32 v2, 4, v2
    v_lshrrev_b32 v3, 16, v3
    v_mad_u32_u24 v2, v3, s13, v2
    v_lshrrev_b32 v3, 2, v3
    v_mad_u32_u24 v18, v3, s14, v2
    v_add_u32 v2, 192, v1
    v_mul_u32_u24 v3, 6554, v2
    v_lshlrev_b32 v2, 4, v2
    v_lshrrev_b32 v3, 16, v3
    v_mad_u32_u24 v2, v3, s13, v2
    v_lshrrev_b32 v3, 2, v3
    v_mad_u32_u24 v19, v3, s14, v2
    v_add_u32 v2, 256, v1
    v_mul_u32_u24 v3, 6554, v2
    v_lshlrev_b32 v2, 4, v2
    v_lshrrev_b32 v3, 16, v3
    v_mad_u32_u24 v2, v3, s13, v2
    v_lshrrev_b32 v3, 2, v3
    v_mad_u32_u24 v20, v3, s14, v2
    s_lshl_b32 s10, s6, 1
    s_and_b32 s9, s10, 0xfffc
    s_min_u32 s9, s9, 1272
    s_sub_u32 s10, s10, s9
    s_lshl_b32 s10, s10, 3
    s_waitcnt lgkmcnt(0)
    s_mov_b32 s48, s16
    s_mov_b32 s49, s17
    s_mov_b32 s50, 2621440
    s_mov_b32 s51, 0x20000
    s_mov_b32 m0, 38304
    s_nop 0
    buffer_load_dwordx4 v16, s[48:51], s11 offen lds
    s_mov_b32 m0, 39328
    s_nop 0
    buffer_load_dwordx4 v17, s[48:51], s11 offen lds
    s_mov_b32 m0, 40352
    s_nop 0
    buffer_load_dwordx4 v18, s[48:51], s11 offen lds
    s_mov_b32 m0, 41376
    s_nop 0
    buffer_load_dwordx4 v19, s[48:51], s11 offen lds
    s_mov_b32 m0, 42400
    s_nop 0
    buffer_load_dwordx4 v20, s[48:51], s11 offen lds
    s_mov_b32 m0, 43424
    s_nop 0
    buffer_load_dwordx4 v16, s[48:51], s12 offen lds
    s_mov_b32 m0, 44448
    s_nop 0
    buffer_load_dwordx4 v17, s[48:51], s12 offen lds
    s_mov_b32 m0, 45472
    s_nop 0
    buffer_load_dwordx4 v18, s[48:51], s12 offen lds
    s_mov_b32 m0, 46496
    s_nop 0
    buffer_load_dwordx4 v19, s[48:51], s12 offen lds
    s_mov_b32 m0, 47520
    s_nop 0
    buffer_load_dwordx4 v20, s[48:51], s12 offen lds
    s_load_dwordx2 s[70:71], s[32:33], s9
    s_mov_b32 s56, s46
    s_mov_b32 s57, s47
    s_mov_b32 s58, 16777216
    s_mov_b32 s59, 0x20000
    s_mov_b32 s96, s46
    s_mov_b32 s97, s47
    s_load_dword s4, s[46:47], 0
    v_lshrrev_b32 v3, 4, v1
    v_lshlrev_b32 v3, 1, v3
    v_bfe_u32 v4, v1, 1, 1
    v_add_u32 v3, v3, v4
    v_lshlrev_b32 v3, 2, v3
    v_bfe_u32 v4, v1, 2, 2
    v_add_u32 v3, v3, v4
    v_mul_u32_u24 v3, 160, v3
    v_and_b32 v4, 1, v1
    v_lshl_add_u32 v3, v4, 3, v3
    v_add_u32 v3, 38304, v3
    v_and_b32 v4, 7, v1
    v_lshlrev_b32 v4, 12, v4
    v_lshrrev_b32 v5, 3, v1
    v_lshl_add_u32 v4, v5, 4, v4
    v_lshlrev_b32 v2, 4, v1
    s_mul_i32 s11, s68, 327680
    s_lshl_b32 s12, s8, 7
    s_add_u32 s11, s11, s12
    s_add_u32 s11, s11, 3145728
    s_waitcnt lgkmcnt(0)
    s_add_u32 s4, s4, 1
    s_lshr_b64 s[70:71], s[70:71], s10
    s_lshl_b32 s12, s70, 16
    v_mov_b32 v8, s12
    s_and_b32 s12, s70, 0xffff0000
    v_mov_b32 v9, s12
    s_lshl_b32 s12, s71, 16
    v_mov_b32 v10, s12
    s_waitcnt vmcnt(0)
    ds_read_b64_tr_b16 v[24:25], v3 offset:0
    ds_read_b64_tr_b16 v[26:27], v3 offset:5120
    ds_read_b64_tr_b16 v[28:29], v3 offset:16
    ds_read_b64_tr_b16 v[30:31], v3 offset:5136
    ds_read_b64_tr_b16 v[32:33], v3 offset:32
    ds_read_b64_tr_b16 v[34:35], v3 offset:5152
    ds_read_b64_tr_b16 v[36:37], v3 offset:48
    ds_read_b64_tr_b16 v[38:39], v3 offset:5168
    ds_read_b64_tr_b16 v[40:41], v3 offset:64
    ds_read_b64_tr_b16 v[42:43], v3 offset:5184
    ds_read_b64_tr_b16 v[44:45], v3 offset:80
    ds_read_b64_tr_b16 v[46:47], v3 offset:5200
    s_waitcnt lgkmcnt(10)
    buffer_store_dwordx4 v[24:27], v4, s[56:59], s11 offen sc1
    s_add_u32 s11, s11, 32768
    ds_read_b64_tr_b16 v[48:49], v3 offset:96
    ds_read_b64_tr_b16 v[50:51], v3 offset:5216
    s_waitcnt lgkmcnt(10)
    buffer_store_dwordx4 v[28:31], v4, s[56:59], s11 offen sc1
    s_add_u32 s11, s11, 32768
    ds_read_b64_tr_b16 v[52:53], v3 offset:112
    ds_read_b64_tr_b16 v[54:55], v3 offset:5232
    s_waitcnt lgkmcnt(10)
    buffer_store_dwordx4 v[32:35], v4, s[56:59], s11 offen sc1
    s_add_u32 s11, s11, 32768
    ds_read_b64_tr_b16 v[56:57], v3 offset:128
    ds_read_b64_tr_b16 v[58:59], v3 offset:5248
    s_waitcnt lgkmcnt(10)
    buffer_store_dwordx4 v[36:39], v4, s[56:59], s11 offen sc1
    s_add_u32 s11, s11, 32768
    ds_read_b64_tr_b16 v[60:61], v3 offset:144
    ds_read_b64_tr_b16 v[62:63], v3 offset:5264
    s_waitcnt lgkmcnt(10)
    buffer_store_dwordx4 v[40:43], v4, s[56:59], s11 offen sc1
    s_add_u32 s11, s11, 32768
    s_waitcnt lgkmcnt(8)
    buffer_store_dwordx4 v[44:47], v4, s[56:59], s11 offen sc1
    s_add_u32 s11, s11, 32768
    s_waitcnt lgkmcnt(6)
    buffer_store_dwordx4 v[48:51], v4, s[56:59], s11 offen sc1
    s_add_u32 s11, s11, 32768
    s_waitcnt lgkmcnt(4)
    buffer_store_dwordx4 v[52:55], v4, s[56:59], s11 offen sc1
    s_add_u32 s11, s11, 32768
    s_waitcnt lgkmcnt(2)
    buffer_store_dwordx4 v[56:59], v4, s[56:59], s11 offen sc1
    s_add_u32 s11, s11, 32768
    s_waitcnt lgkmcnt(0)
    buffer_store_dwordx4 v[60:63], v4, s[56:59], s11 offen sc1
    s_lshl_b32 s9, s5, 7
    s_add_u32 s9, s9, 65536
    s_lshl_b32 s12, s68, 10
    s_add_u32 s12, s12, s69
    s_lshl_b32 s12, s12, 2
    s_add_u32 s12, s12, 65536
    s_waitcnt vmcnt(0)
    v_mov_b32 v4, s4
    v_mul_u32_u24 v5, 128, v1
    s_mov_b32 exec_lo, 0xffffffff
    s_mov_b32 exec_hi, 0
    buffer_store_dword v4, v5, s[56:59], s12 offen sc1
    s_mov_b64 exec, -1
    s_mov_b32 s15, 20000
Lsp_14:
    s_load_dwordx16 s[16:31], s[96:97], s9 glc
    s_load_dwordx16 s[32:47], s[96:97], s9 offset:64 glc
    s_waitcnt lgkmcnt(0)
    s_xor_b32 s16, s16, s4
    s_xor_b32 s17, s17, s4
    s_xor_b32 s18, s18, s4
    s_xor_b32 s19, s19, s4
    s_xor_b32 s20, s20, s4
    s_xor_b32 s21, s21, s4
    s_xor_b32 s22, s22, s4
    s_xor_b32 s23, s23, s4
    s_xor_b32 s24, s24, s4
    s_xor_b32 s25, s25, s4
    s_xor_b32 s26, s26, s4
    s_xor_b32 s27, s27, s4
    s_xor_b32 s28, s28, s4
    s_xor_b32 s29, s29, s4
    s_xor_b32 s30, s30, s4
    s_xor_b32 s31, s31, s4
    s_xor_b32 s32, s32, s4
    s_xor_b32 s33, s33, s4
    s_xor_b32 s34, s34, s4
    s_xor_b32 s35, s35, s4
    s_xor_b32 s36, s36, s4
    s_xor_b32 s37, s37, s4
    s_xor_b32 s38, s38, s4
    s_xor_b32 s39, s39, s4
    s_xor_b32 s40, s40, s4
    s_xor_b32 s41, s41, s4
    s_xor_b32 s42, s42, s4
    s_xor_b32 s43, s43, s4
    s_xor_b32 s44, s44, s4
    s_xor_b32 s45, s45, s4
    s_xor_b32 s46, s46, s4
    s_xor_b32 s47, s47, s4
    s_or_b64 s[16:17], s[16:17], s[18:19]
    s_or_b64 s[16:17], s[16:17], s[20:21]
    s_or_b64 s[16:17], s[16:17], s[22:23]
    s_or_b64 s[16:17], s[16:17], s[24:25]
    s_or_b64 s[16:17], s[16:17], s[26:27]
    s_or_b64 s[16:17], s[16:17], s[28:29]
    s_or_b64 s[16:17], s[16:17], s[30:31]
    s_or_b64 s[16:17], s[16:17], s[32:33]
    s_or_b64 s[16:17], s[16:17], s[34:35]
    s_or_b64 s[16:17], s[16:17], s[36:37]
    s_or_b64 s[16:17], s[16:17], s[38:39]
    s_or_b64 s[16:17], s[16:17], s[40:41]
    s_or_b64 s[16:17], s[16:17], s[42:43]
    s_or_b64 s[16:17], s[16:17], s[44:45]
    s_or_b64 s[16:17], s[16:17], s[46:47]
    s_cbranch_scc0 Lsd_15
    s_setprio 0
    s_sleep 1
    s_sub_u32 s15, s15, 1
    s_cbranch_scc0 Lsp_14
Lsd_15:
    s_setprio 2
    s_lshl_b32 s9, s6, 12
    s_add_u32 s9, s9, 3145728
    buffer_load_dwordx4 v[16:19], v2, s[56:59], s9 offen offset:0 sc1 nt
    buffer_load_dwordx4 v[20:23], v2, s[56:59], s9 offen offset:1024 sc1 nt
    buffer_load_dwordx4 v[24:27], v2, s[56:59], s9 offen offset:2048 sc1 nt
    buffer_load_dwordx4 v[28:31], v2, s[56:59], s9 offen offset:3072 sc1 nt
    s_add_u32 s9, s9, 4096
    buffer_load_dwordx4 v[32:35], v2, s[56:59], s9 offen offset:0 sc1 nt
    buffer_load_dwordx4 v[36:39], v2, s[56:59], s9 offen offset:1024 sc1 nt
    buffer_load_dwordx4 v[40:43], v2, s[56:59], s9 offen offset:2048 sc1 nt
    buffer_load_dwordx4 v[44:47], v2, s[56:59], s9 offen offset:3072 sc1 nt
    s_add_u32 s9, s9, 4096
    s_cmp_eq_u32 s7, 2
    s_cselect_b32 s9, 0x7ff00000, s9
    buffer_load_dwordx4 v[48:51], v2, s[56:59], s9 offen offset:0 sc1 nt
    buffer_load_dwordx4 v[52:55], v2, s[56:59], s9 offen offset:1024 sc1 nt
    buffer_load_dwordx4 v[56:59], v2, s[56:59], s9 offen offset:2048 sc1 nt
    buffer_load_dwordx4 v[60:63], v2, s[56:59], s9 offen offset:3072 sc1 nt
    v_and_b32 v6, 1, v1
    v_lshlrev_b32 v6, 4, v6
    v_lshrrev_b32 v7, 1, v1
    s_mul_i32 s9, s7, 3
    s_sub_u32 s9, s9, 1
    v_min_u32 v7, s9, v7
    v_mul_u32_u24 v7, 4160, v7
    v_add_u32 v6, v6, v7
    v_mov_b32 v12, 0
    v_mov_b32 v13, 0
    v_mov_b32 v14, 0
    v_mov_b32 v15, 0
    v_add_u32 v5, 38304, v2
    ds_write_b128 v6, v[12:15] offset:38304
    s_waitcnt vmcnt(8)
    v_mov_b32 v112, 0
    v_mov_b32 v124, 0
    ds_write_b128 v5, v[16:19] offset:32
    v_mov_b32_dpp v112, v19 wave_shr:1 row_mask:0xf bank_mask:0xf
    v_mov_b32_dpp v124, v18 wave_shr:1 row_mask:0xf bank_mask:0xf
    v_mov_b32 v113, v16
    v_mov_b32 v114, v17
    v_mov_b32 v115, v18
    v_alignbit_b32 v116, v16, v112, 16
    v_alignbit_b32 v117, v17, v113, 16
    v_alignbit_b32 v118, v18, v114, 16
    v_alignbit_b32 v119, v19, v115, 16
    v_alignbit_b32 v64, v112, v124, 16
    v_alignbit_b32 v65, v113, v112, 16
    v_alignbit_b32 v66, v114, v113, 16
    v_alignbit_b32 v67, v115, v114, 16
    ds_write_b128 v5, v[116:119] offset:4192
    ds_write_b128 v5, v[112:115] offset:8352
    v_mov_b32_dpp v128, v19 wave_ror:1 row_mask:0xf bank_mask:0xf
    v_mov_b32_dpp v140, v18 wave_ror:1 row_mask:0xf bank_mask:0xf
    ds_write_b128 v5, v[20:23] offset:1056
    v_mov_b32_dpp v128, v23 wave_shr:1 row_mask:0xf bank_mask:0xf
    v_mov_b32_dpp v140, v22 wave_shr:1 row_mask:0xf bank_mask:0xf
    v_mov_b32 v129, v20
    v_mov_b32 v130, v21
    v_mov_b32 v131, v22
    v_alignbit_b32 v132, v20, v128, 16
    v_alignbit_b32 v133, v21, v129, 16
    v_alignbit_b32 v134, v22, v130, 16
    v_alignbit_b32 v135, v23, v131, 16
    v_alignbit_b32 v68, v128, v140, 16
    v_alignbit_b32 v69, v129, v128, 16
    v_alignbit_b32 v70, v130, v129, 16
    v_alignbit_b32 v71, v131, v130, 16
    ds_write_b128 v5, v[132:135] offset:5216
    ds_write_b128 v5, v[128:131] offset:9376
    v_mov_b32_dpp v112, v23 wave_ror:1 row_mask:0xf bank_mask:0xf
    v_mov_b32_dpp v124, v22 wave_ror:1 row_mask:0xf bank_mask:0xf
    ds_write_b128 v5, v[24:27] offset:2080
    v_mov_b32_dpp v112, v27 wave_shr:1 row_mask:0xf bank_mask:0xf
    v_mov_b32_dpp v124, v26 wave_shr:1 row_mask:0xf bank_mask:0xf
    v_mov_b32 v113, v24
    v_mov_b32 v114, v25
    v_mov_b32 v115, v26
    v_alignbit_b32 v116, v24, v112, 16
    v_alignbit_b32 v117, v25, v113, 16
    v_alignbit_b32 v118, v26, v114, 16
    v_alignbit_b32 v119, v27, v115, 16
    v_alignbit_b32 v72, v112, v124, 16
    v_alignbit_b32 v73, v113, v112, 16
    v_alignbit_b32 v74, v114, v113, 16
    v_alignbit_b32 v75, v115, v114, 16
    ds_write_b128 v5, v[116:119] offset:6240
    ds_write_b128 v5, v[112:115] offset:10400
    v_mov_b32_dpp v128, v27 wave_ror:1 row_mask:0xf bank_mask:0xf
    v_mov_b32_dpp v140, v26 wave_ror:1 row_mask:0xf bank_mask:0xf
    ds_write_b128 v5, v[28:31] offset:3104
    v_mov_b32_dpp v128, v31 wave_shr:1 row_mask:0xf bank_mask:0xf
    v_mov_b32_dpp v140, v30 wave_shr:1 row_mask:0xf bank_mask:0xf
    v_mov_b32 v129, v28
    v_mov_b32 v130, v29
    v_mov_b32 v131, v30
    v_alignbit_b32 v132, v28, v128, 16
    v_alignbit_b32 v133, v29, v129, 16
    v_alignbit_b32 v134, v30, v130, 16
    v_alignbit_b32 v135, v31, v131, 16
    v_alignbit_b32 v76, v128, v140, 16
    v_alignbit_b32 v77, v129, v128, 16
    v_alignbit_b32 v78, v130, v129, 16
    v_alignbit_b32 v79, v131, v130, 16
    ds_write_b128 v5, v[132:135] offset:7264
    ds_write_b128 v5, v[128:131] offset:11424
    s_waitcnt vmcnt(4)
    v_mov_b32 v112, 0
    v_mov_b32 v124, 0
    ds_write_b128 v5, v[32:35] offset:12512
    v_mov_b32_dpp v112, v35 wave_shr:1 row_mask:0xf bank_mask:0xf
    v_mov_b32_dpp v124, v34 wave_shr:1 row_mask:0xf bank_mask:0xf
    v_mov_b32 v113, v32
    v_mov_b32 v114, v33
    v_mov_b32 v115, v34
    v_alignbit_b32 v116, v32, v112, 16
    v_alignbit_b32 v117, v33, v113, 16
    v_alignbit_b32 v118, v34, v114, 16
    v_alignbit_b32 v119, v35, v115, 16
    v_alignbit_b32 v80, v112, v124, 16
    v_alignbit_b32 v81, v113, v112, 16
    v_alignbit_b32 v82, v114, v113, 16
    v_alignbit_b32 v83, v115, v114, 16
    ds_write_b128 v5, v[116:119] offset:16672
    ds_write_b128 v5, v[112:115] offset:20832
    v_mov_b32_dpp v128, v35 wave_ror:1 row_mask:0xf bank_mask:0xf
    v_mov_b32_dpp v140, v34 wave_ror:1 row_mask:0xf bank_mask:0xf
    ds_write_b128 v5, v[36:39] offset:13536
    v_mov_b32_dpp v128, v39 wave_shr:1 row_mask:0xf bank_mask:0xf
    v_mov_b32_dpp v140, v38 wave_shr:1 row_mask:0xf bank_mask:0xf
    v_mov_b32 v129, v36
    v_mov_b32 v130, v37
    v_mov_b32 v131, v38
    v_alignbit_b32 v132, v36, v128, 16
    v_alignbit_b32 v133, v37, v129, 16
    v_alignbit_b32 v134, v38, v130, 16
    v_alignbit_b32 v135, v39, v131, 16
    v_alignbit_b32 v84, v128, v140, 16
    v_alignbit_b32 v85, v129, v128, 16
    v_alignbit_b32 v86, v130, v129, 16
    v_alignbit_b32 v87, v131, v130, 16
    ds_write_b128 v5, v[132:135] offset:17696
    ds_write_b128 v5, v[128:131] offset:21856
    v_mov_b32_dpp v112, v39 wave_ror:1 row_mask:0xf bank_mask:0xf
    v_mov_b32_dpp v124, v38 wave_ror:1 row_mask:0xf bank_mask:0xf
    ds_write_b128 v5, v[40:43] offset:14560
    v_mov_b32_dpp v112, v43 wave_shr:1 row_mask:0xf bank_mask:0xf
    v_mov_b32_dpp v124, v42 wave_shr:1 row_mask:0xf bank_mask:0xf
    v_mov_b32 v113, v40
    v_mov_b32 v114, v41
    v_mov_b32 v115, v42
    v_alignbit_b32 v116, v40, v112, 16
    v_alignbit_b32 v117, v41, v113, 16
    v_alignbit_b32 v118, v42, v114, 16
    v_alignbit_b32 v119, v43, v115, 16
    v_alignbit_b32 v88, v112, v124, 16
    v_alignbit_b32 v89, v113, v112, 16
    v_alignbit_b32 v90, v114, v113, 16
    v_alignbit_b32 v91, v115, v114, 16
    ds_write_b128 v5, v[116:119] offset:18720
    ds_write_b128 v5, v[112:115] offset:22880
    v_mov_b32_dpp v128, v43 wave_ror:1 row_mask:0xf bank_mask:0xf
    v_mov_b32_dpp v140, v42 wave_ror:1 row_mask:0xf bank_mask:0xf
    ds_write_b128 v5, v[44:47] offset:15584
    v_mov_b32_dpp v128, v47 wave_shr:1 row_mask:0xf bank_mask:0xf
    v_mov_b32_dpp v140, v46 wave_shr:1 row_mask:0xf bank_mask:0xf
    v_mov_b32 v129, v44
    v_mov_b32 v130, v45
    v_mov_b32 v131, v46
    v_alignbit_b32 v132, v44, v128, 16
    v_alignbit_b32 v133, v45, v129, 16
    v_alignbit_b32 v134, v46, v130, 16
    v_alignbit_b32 v135, v47, v131, 16
    v_alignbit_b32 v92, v128, v140, 16
    v_alignbit_b32 v93, v129, v128, 16
    v_alignbit_b32 v94, v130, v129, 16
    v_alignbit_b32 v95, v131, v130, 16
    ds_write_b128 v5, v[132:135] offset:19744
    ds_write_b128 v5, v[128:131] offset:23904
    s_waitcnt vmcnt(0)
    s_cmp_eq_u32 s7, 2
    s_cbranch_scc1 LW3c
    v_mov_b32 v112, 0
    v_mov_b32 v124, 0
    ds_write_b128 v5, v[48:51] offset:24992
    v_mov_b32_dpp v112, v51 wave_shr:1 row_mask:0xf bank_mask:0xf
    v_mov_b32_dpp v124, v50 wave_shr:1 row_mask:0xf bank_mask:0xf
    v_mov_b32 v113, v48
    v_mov_b32 v114, v49
    v_mov_b32 v115, v50
    v_alignbit_b32 v116, v48, v112, 16
    v_alignbit_b32 v117, v49, v113, 16
    v_alignbit_b32 v118, v50, v114, 16
    v_alignbit_b32 v119, v51, v115, 16
    v_alignbit_b32 v96, v112, v124, 16
    v_alignbit_b32 v97, v113, v112, 16
    v_alignbit_b32 v98, v114, v113, 16
    v_alignbit_b32 v99, v115, v114, 16
    ds_write_b128 v5, v[116:119] offset:29152
    ds_write_b128 v5, v[112:115] offset:33312
    v_mov_b32_dpp v128, v51 wave_ror:1 row_mask:0xf bank_mask:0xf
    v_mov_b32_dpp v140, v50 wave_ror:1 row_mask:0xf bank_mask:0xf
    ds_write_b128 v5, v[52:55] offset:26016
    v_mov_b32_dpp v128, v55 wave_shr:1 row_mask:0xf bank_mask:0xf
    v_mov_b32_dpp v140, v54 wave_shr:1 row_mask:0xf bank_mask:0xf
    v_mov_b32 v129, v52
    v_mov_b32 v130, v53
    v_mov_b32 v131, v54
    v_alignbit_b32 v132, v52, v128, 16
    v_alignbit_b32 v133, v53, v129, 16
    v_alignbit_b32 v134, v54, v130, 16
    v_alignbit_b32 v135, v55, v131, 16
    v_alignbit_b32 v100, v128, v140, 16
    v_alignbit_b32 v101, v129, v128, 16
    v_alignbit_b32 v102, v130, v129, 16
    v_alignbit_b32 v103, v131, v130, 16
    ds_write_b128 v5, v[132:135] offset:30176
    ds_write_b128 v5, v[128:131] offset:34336
    v_mov_b32_dpp v112, v55 wave_ror:1 row_mask:0xf bank_mask:0xf
    v_mov_b32_dpp v124, v54 wave_ror:1 row_mask:0xf bank_mask:0xf
    ds_write_b128 v5, v[56:59] offset:27040
    v_mov_b32_dpp v112, v59 wave_shr:1 row_mask:0xf bank_mask:0xf
    v_mov_b32_dpp v124, v58 wave_shr:1 row_mask:0xf bank_mask:0xf
    v_mov_b32 v113, v56
    v_mov_b32 v114, v57
    v_mov_b32 v115, v58
    v_alignbit_b32 v116, v56, v112, 16
    v_alignbit_b32 v117, v57, v113, 16
    v_alignbit_b32 v118, v58, v114, 16
    v_alignbit_b32 v119, v59, v115, 16
    v_alignbit_b32 v104, v112, v124, 16
    v_alignbit_b32 v105, v113, v112, 16
    v_alignbit_b32 v106, v114, v113, 16
    v_alignbit_b32 v107, v115, v114, 16
    ds_write_b128 v5, v[116:119] offset:31200
    ds_write_b128 v5, v[112:115] offset:35360
    v_mov_b32_dpp v128, v59 wave_ror:1 row_mask:0xf bank_mask:0xf
    v_mov_b32_dpp v140, v58 wave_ror:1 row_mask:0xf bank_mask:0xf
    ds_write_b128 v5, v[60:63] offset:28064
    v_mov_b32_dpp v128, v63 wave_shr:1 row_mask:0xf bank_mask:0xf
    v_mov_b32_dpp v140, v62 wave_shr:1 row_mask:0xf bank_mask:0xf
    v_mov_b32 v129, v60
    v_mov_b32 v130, v61
    v_mov_b32 v131, v62
    v_alignbit_b32 v132, v60, v128, 16
    v_alignbit_b32 v133, v61, v129, 16
    v_alignbit_b32 v134, v62, v130, 16
    v_alignbit_b32 v135, v63, v131, 16
    v_alignbit_b32 v108, v128, v140, 16
    v_alignbit_b32 v109, v129, v128, 16
    v_alignbit_b32 v110, v130, v129, 16
    v_alignbit_b32 v111, v131, v130, 16
    ds_write_b128 v5, v[132:135] offset:32224
    ds_write_b128 v5, v[128:131] offset:36384
LW3c:
    s_mov_b32 s8, 0
    s_mul_i32 s13, s8, 12768
    s_mul_i32 s14, s8, 12480
    s_add_u32 s14, s14, 38304
    v_bfe_u32 v6, v1, 2, 2
    v_mul_u32_u24 v7, 4160, v6
    v_add_u32 v7, s14, v7
    v_mov_b32 v3, s13
    v_cmp_eq_u32 vcc, 3, v6
    v_and_b32 v6, 3, v1
    s_nop 0
    v_cndmask_b32 v3, v7, v3, vcc
    v_lshl_add_u32 v3, v6, 3, v3
    v_lshrrev_b32 v7, 4, v1
    v_lshlrev_b32 v7, 4, v7
    v_sub_u32 v3, v3, v7
    v_add_u32 v3, 32, v3
    v_and_b32 v6, 15, v1
    v_lshl_add_u32 v4, v6, 5, v7
    s_add_u32 s13, s13, 4160
    v_add_u32 v4, s13, v4
    v_mov_b32 v6, 12480
    v_mov_b32 v7, 12768
    v_cndmask_b32 v6, v6, v7, vcc
    v_add_u32 v11, v3, v6
    v_add_u32 v16, v11, v6
    v_and_b32 v6, 15, v1
    v_lshrrev_b32 v7, 4, v1
    v_lshlrev_b32 v5, 5, v6
    v_lshl_add_u32 v5, v7, 3, v5
    v_lshlrev_b32 v6, 5, v6
    v_lshrrev_b32 v7, 5, v1
    v_lshl_add_u32 v6, v7, 4, v6
    v_bfe_u32 v7, v1, 4, 1
    v_lshl_add_u32 v0, v7, 9, v6
    v_and_b32 v6, 1, v1
    v_lshlrev_b32 v6, 4, v6
    v_bfe_u32 v7, v1, 1, 2
    v_min_u32 v7, 2, v7
    v_mul_u32_u24 v7, 12768, v7
    v_add_u32 v6, v6, v7
    s_mov_b32 s12, 0xffff0000
    s_lshl_b32 s9, s6, 12
    s_add_u32 s9, s9, 6291456
    s_waitcnt lgkmcnt(0)
    s_barrier
    ds_write_b128 v6, v[12:15]
    ds_write_b128 v2, v[64:67] offset:32
    ds_write_b128 v2, v[68:71] offset:1056
    ds_write_b128 v2, v[72:75] offset:2080
    ds_write_b128 v2, v[76:79] offset:3104
    ds_write_b128 v2, v[80:83] offset:12800
    ds_write_b128 v2, v[84:87] offset:13824
    ds_write_b128 v2, v[88:91] offset:14848
    ds_write_b128 v2, v[92:95] offset:15872
    ds_write_b128 v2, v[96:99] offset:25568
    ds_write_b128 v2, v[100:103] offset:26592
    ds_write_b128 v2, v[104:107] offset:27616
    ds_write_b128 v2, v[108:111] offset:28640
    ds_read_b64 v[20:21], v5 offset:39360
    ds_read_b64 v[22:23], v5 offset:39872
    ds_read_b64 v[24:25], v5 offset:51840
    ds_read_b64 v[26:27], v5 offset:52352
    ds_read_b64 v[28:29], v5 offset:64320
    ds_read_b64 v[30:31], v5 offset:64832
    s_waitcnt lgkmcnt(0)
    s_barrier
    s_setprio 2
    ds_read_b128 v[104:107], v4 offset:0
    ds_read_b64_tr_b16 v[64:65], v3 offset:480
    ds_read_b64_tr_b16 v[66:67], v3 offset:472
    ds_read_b128 v[108:111], v4 offset:512
    ds_read_b64_tr_b16 v[68:69], v3 offset:992
    ds_read_b64_tr_b16 v[70:71], v3 offset:984
    ds_read_b128 v[112:115], v4 offset:1024
    ds_read_b64_tr_b16 v[72:73], v3 offset:1504
    ds_read_b64_tr_b16 v[74:75], v3 offset:1496
    ds_read_b128 v[116:119], v4 offset:1536
    ds_read_b64_tr_b16 v[76:77], v3 offset:2016
    ds_read_b64_tr_b16 v[78:79], v3 offset:2008
    s_waitcnt lgkmcnt(0)
    v_mfma_f32_16x16x32_bf16 v[144:147], v[72:75], v[104:107], 0
    ds_read_b128 v[124:127], v4 offset:64
    ds_read_b64_tr_b16 v[84:85], v3 offset:416
    v_mfma_f32_16x16x32_bf16 v[148:151], v[76:79], v[104:107], 0
    ds_read_b64_tr_b16 v[86:87], v3 offset:408
    ds_read_b128 v[128:131], v4 offset:576
    v_mfma_f32_16x16x32_bf16 v[144:147], v[68:71], v[108:111], v[144:147]
    ds_read_b64_tr_b16 v[88:89], v3 offset:928
    ds_read_b64_tr_b16 v[90:91], v3 offset:920
    v_mfma_f32_16x16x32_bf16 v[148:151], v[72:75], v[108:111], v[148:151]
    ds_read_b128 v[132:135], v4 offset:1088
    ds_read_b64_tr_b16 v[92:93], v3 offset:1440
    v_mfma_f32_16x16x32_bf16 v[144:147], v[64:67], v[112:115], v[144:147]
    ds_read_b64_tr_b16 v[94:95], v3 offset:1432
    ds_read_b128 v[136:139], v4 offset:1600
    v_mfma_f32_16x16x32_bf16 v[148:151], v[68:71], v[112:115], v[148:151]
    ds_read_b64_tr_b16 v[96:97], v3 offset:1952
    ds_read_b64_tr_b16 v[98:99], v3 offset:1944
    v_mfma_f32_16x16x32_bf16 v[148:151], v[64:67], v[116:119], v[148:151]
    s_waitcnt lgkmcnt(0)
    v_mfma_f32_16x16x32_bf16 v[144:147], v[92:95], v[124:127], v[144:147]
    ds_read_b128 v[104:107], v4 offset:128
    ds_read_b64_tr_b16 v[64:65], v3 offset:352
    v_lshlrev_b32 v32, 16, v20
    v_and_b32 v33, s12, v20
    v_mfma_f32_16x16x32_bf16 v[148:151], v[96:99], v[124:127], v[148:151]
    ds_read_b64_tr_b16 v[66:67], v3 offset:344
    ds_read_b128 v[108:111], v4 offset:640
    v_lshlrev_b32 v34, 16, v21
    v_and_b32 v35, s12, v21
    v_mfma_f32_16x16x32_bf16 v[144:147], v[88:91], v[128:131], v[144:147]
    ds_read_b64_tr_b16 v[68:69], v3 offset:864
    ds_read_b64_tr_b16 v[70:71], v3 offset:856
    v_mul_f32 v32, v8, v32
    v_mul_f32 v33, v8, v33
    v_mfma_f32_16x16x32_bf16 v[148:151], v[92:95], v[128:131], v[148:151]
    ds_read_b128 v[112:115], v4 offset:1152
    ds_read_b64_tr_b16 v[72:73], v3 offset:1376
    v_mul_f32 v34, v8, v34
    v_mul_f32 v35, v8, v35
    v_mfma_f32_16x16x32_bf16 v[144:147], v[84:87], v[132:135], v[144:147]
    ds_read_b64_tr_b16 v[74:75], v3 offset:1368
    ds_read_b128 v[116:119], v4 offset:1664
    v_cvt_pk_bf16_f32 v32, 0, v32
    v_cvt_pk_bf16_f32 v33, 0, v33
    v_mfma_f32_16x16x32_bf16 v[148:151], v[88:91], v[132:135], v[148:151]
    ds_read_b64_tr_b16 v[76:77], v3 offset:1888
    ds_read_b64_tr_b16 v[78:79], v3 offset:1880
    v_cvt_pk_bf16_f32 v34, 0, v34
    v_cvt_pk_bf16_f32 v35, 0, v35
    v_mfma_f32_16x16x32_bf16 v[148:151], v[84:87], v[136:139], v[148:151]
    v_lshlrev_b32 v36, 16, v22
    v_and_b32 v37, s12, v22
    s_waitcnt lgkmcnt(0)
    v_mfma_f32_16x16x32_bf16 v[144:147], v[72:75], v[104:107], v[144:147]
    ds_read_b128 v[124:127], v4 offset:192
    ds_read_b64_tr_b16 v[84:85], v3 offset:288
    v_lshlrev_b32 v38, 16, v23
    v_and_b32 v39, s12, v23
    v_mfma_f32_16x16x32_bf16 v[148:151], v[76:79], v[104:107], v[148:151]
    ds_read_b64_tr_b16 v[86:87], v3 offset:280
    ds_read_b128 v[128:131], v4 offset:704
    v_mul_f32 v36, v8, v36
    v_mul_f32 v37, v8, v37
    v_mfma_f32_16x16x32_bf16 v[144:147], v[68:71], v[108:111], v[144:147]
    ds_read_b64_tr_b16 v[88:89], v3 offset:800
    ds_read_b64_tr_b16 v[90:91], v3 offset:792
    v_mul_f32 v38, v8, v38
    v_mul_f32 v39, v8, v39
    v_mfma_f32_16x16x32_bf16 v[148:151], v[72:75], v[108:111], v[148:151]
    ds_read_b128 v[132:135], v4 offset:1216
    ds_read_b64_tr_b16 v[92:93], v3 offset:1312
    v_cvt_pk_bf16_f32 v36, 0, v36
    v_cvt_pk_bf16_f32 v37, 0, v37
    v_mfma_f32_16x16x32_bf16 v[144:147], v[64:67], v[112:115], v[144:147]
    ds_read_b64_tr_b16 v[94:95], v3 offset:1304
    ds_read_b128 v[136:139], v4 offset:1728
    v_cvt_pk_bf16_f32 v38, 0, v38
    v_cvt_pk_bf16_f32 v39, 0, v39
    v_mfma_f32_16x16x32_bf16 v[148:151], v[68:71], v[112:115], v[148:151]
    ds_read_b64_tr_b16 v[96:97], v3 offset:1824
    ds_read_b64_tr_b16 v[98:99], v3 offset:1816
    v_lshlrev_b32 v40, 16, v24
    v_and_b32 v41, s12, v24
    v_mfma_f32_16x16x32_bf16 v[148:151], v[64:67], v[116:119], v[148:151]
    v_lshlrev_b32 v42, 16, v25
    v_and_b32 v43, s12, v25
    s_waitcnt lgkmcnt(0)
    v_mfma_f32_16x16x32_bf16 v[144:147], v[92:95], v[124:127], v[144:147]
    ds_read_b128 v[104:107], v4 offset:256
    ds_read_b64_tr_b16 v[64:65], v3 offset:224
    v_mul_f32 v40, v9, v40
    v_mul_f32 v41, v9, v41
    v_mfma_f32_16x16x32_bf16 v[148:151], v[96:99], v[124:127], v[148:151]
    ds_read_b64_tr_b16 v[66:67], v3 offset:216
    ds_read_b128 v[108:111], v4 offset:768
    v_mul_f32 v42, v9, v42
    v_mul_f32 v43, v9, v43
    v_mfma_f32_16x16x32_bf16 v[144:147], v[88:91], v[128:131], v[144:147]
    ds_read_b64_tr_b16 v[68:69], v3 offset:736
    ds_read_b64_tr_b16 v[70:71], v3 offset:728
    v_cvt_pk_bf16_f32 v40, 0, v40
    v_cvt_pk_bf16_f32 v41, 0, v41
    v_mfma_f32_16x16x32_bf16 v[148:151], v[92:95], v[128:131], v[148:151]
    ds_read_b128 v[112:115], v4 offset:1280
    ds_read_b64_tr_b16 v[72:73], v3 offset:1248
    v_cvt_pk_bf16_f32 v42, 0, v42
    v_cvt_pk_bf16_f32 v43, 0, v43
    v_mfma_f32_16x16x32_bf16 v[144:147], v[84:87], v[132:135], v[144:147]
    ds_read_b64_tr_b16 v[74:75], v3 offset:1240
    ds_read_b128 v[116:119], v4 offset:1792
    v_lshlrev_b32 v44, 16, v26
    v_and_b32 v45, s12, v26
    v_mfma_f32_16x16x32_bf16 v[148:151], v[88:91], v[132:135], v[148:151]
    ds_read_b64_tr_b16 v[76:77], v3 offset:1760
    ds_read_b64_tr_b16 v[78:79], v3 offset:1752
    v_lshlrev_b32 v46, 16, v27
    v_and_b32 v47, s12, v27
    v_mfma_f32_16x16x32_bf16 v[148:151], v[84:87], v[136:139], v[148:151]
    v_mul_f32 v44, v9, v44
    v_mul_f32 v45, v9, v45
    s_waitcnt lgkmcnt(0)
    v_mfma_f32_16x16x32_bf16 v[144:147], v[72:75], v[104:107], v[144:147]
    ds_read_b128 v[124:127], v4 offset:320
    ds_read_b64_tr_b16 v[84:85], v3 offset:160
    v_mul_f32 v46, v9, v46
    v_mul_f32 v47, v9, v47
    v_mfma_f32_16x16x32_bf16 v[148:151], v[76:79], v[104:107], v[148:151]
    ds_read_b64_tr_b16 v[86:87], v3 offset:152
    ds_read_b128 v[128:131], v4 offset:832
    v_cvt_pk_bf16_f32 v44, 0, v44
    v_cvt_pk_bf16_f32 v45, 0, v45
    v_mfma_f32_16x16x32_bf16 v[144:147], v[68:71], v[108:111], v[144:147]
    ds_read_b64_tr_b16 v[88:89], v3 offset:672
    ds_read_b64_tr_b16 v[90:91], v3 offset:664
    v_cvt_pk_bf16_f32 v46, 0, v46
    v_cvt_pk_bf16_f32 v47, 0, v47
    v_mfma_f32_16x16x32_bf16 v[148:151], v[72:75], v[108:111], v[148:151]
    ds_read_b128 v[132:135], v4 offset:1344
    ds_read_b64_tr_b16 v[92:93], v3 offset:1184
    v_mfma_f32_16x16x32_bf16 v[144:147], v[64:67], v[112:115], v[144:147]
    ds_read_b64_tr_b16 v[94:95], v3 offset:1176
    ds_read_b128 v[136:139], v4 offset:1856
    v_mfma_f32_16x16x32_bf16 v[148:151], v[68:71], v[112:115], v[148:151]
    ds_read_b64_tr_b16 v[96:97], v3 offset:1696
    ds_read_b64_tr_b16 v[98:99], v3 offset:1688
    v_mfma_f32_16x16x32_bf16 v[148:151], v[64:67], v[116:119], v[148:151]
    s_waitcnt lgkmcnt(0)
    v_mfma_f32_16x16x32_bf16 v[144:147], v[92:95], v[124:127], v[144:147]
    ds_read_b128 v[104:107], v4 offset:384
    ds_read_b64_tr_b16 v[64:65], v3 offset:96
    v_mfma_f32_16x16x32_bf16 v[148:151], v[96:99], v[124:127], v[148:151]
    ds_read_b64_tr_b16 v[66:67], v3 offset:88
    ds_read_b128 v[108:111], v4 offset:896
    v_mfma_f32_16x16x32_bf16 v[144:147], v[88:91], v[128:131], v[144:147]
    ds_read_b64_tr_b16 v[68:69], v3 offset:608
    ds_read_b64_tr_b16 v[70:71], v3 offset:600
    v_mfma_f32_16x16x32_bf16 v[148:151], v[92:95], v[128:131], v[148:151]
    ds_read_b128 v[112:115], v4 offset:1408
    ds_read_b64_tr_b16 v[72:73], v3 offset:1120
    v_mfma_f32_16x16x32_bf16 v[144:147], v[84:87], v[132:135], v[144:147]
    ds_read_b64_tr_b16 v[74:75], v3 offset:1112
    ds_read_b128 v[116:119], v4 offset:1920
    v_mfma_f32_16x16x32_bf16 v[148:151], v[88:91], v[132:135], v[148:151]
    ds_read_b64_tr_b16 v[76:77], v3 offset:1632
    ds_read_b64_tr_b16 v[78:79], v3 offset:1624
    v_mfma_f32_16x16x32_bf16 v[148:151], v[84:87], v[136:139], v[148:151]
    s_waitcnt lgkmcnt(0)
    v_mfma_f32_16x16x32_bf16 v[144:147], v[72:75], v[104:107], v[144:147]
    ds_read_b128 v[124:127], v4 offset:448
    ds_read_b64_tr_b16 v[84:85], v3 offset:32
    v_mfma_f32_16x16x32_bf16 v[148:151], v[76:79], v[104:107], v[148:151]
    ds_read_b64_tr_b16 v[86:87], v3 offset:24
    ds_read_b128 v[128:131], v4 offset:960
    v_mfma_f32_16x16x32_bf16 v[144:147], v[68:71], v[108:111], v[144:147]
    ds_read_b64_tr_b16 v[88:89], v3 offset:544
    ds_read_b64_tr_b16 v[90:91], v3 offset:536
    v_mfma_f32_16x16x32_bf16 v[148:151], v[72:75], v[108:111], v[148:151]
    ds_read_b128 v[132:135], v4 offset:1472
    ds_read_b64_tr_b16 v[92:93], v3 offset:1056
    v_mfma_f32_16x16x32_bf16 v[144:147], v[64:67], v[112:115], v[144:147]
    ds_read_b64_tr_b16 v[94:95], v3 offset:1048
    ds_read_b128 v[136:139], v4 offset:1984
    v_mfma_f32_16x16x32_bf16 v[148:151], v[68:71], v[112:115], v[148:151]
    ds_read_b64_tr_b16 v[96:97], v3 offset:1568
    ds_read_b64_tr_b16 v[98:99], v3 offset:1560
    v_mfma_f32_16x16x32_bf16 v[148:151], v[64:67], v[116:119], v[148:151]
    s_waitcnt lgkmcnt(0)
    v_mfma_f32_16x16x32_bf16 v[144:147], v[92:95], v[124:127], v[144:147]
    ds_read_b128 v[104:107], v4 offset:12768
    ds_read_b64_tr_b16 v[64:65], v11 offset:480
    v_mfma_f32_16x16x32_bf16 v[148:151], v[96:99], v[124:127], v[148:151]
    ds_read_b64_tr_b16 v[66:67], v11 offset:472
    ds_read_b128 v[108:111], v4 offset:13280
    v_mfma_f32_16x16x32_bf16 v[144:147], v[88:91], v[128:131], v[144:147]
    ds_read_b64_tr_b16 v[68:69], v11 offset:992
    ds_read_b64_tr_b16 v[70:71], v11 offset:984
    v_mfma_f32_16x16x32_bf16 v[148:151], v[92:95], v[128:131], v[148:151]
    ds_read_b128 v[112:115], v4 offset:13792
    ds_read_b64_tr_b16 v[72:73], v11 offset:1504
    v_mfma_f32_16x16x32_bf16 v[144:147], v[84:87], v[132:135], v[144:147]
    ds_read_b64_tr_b16 v[74:75], v11 offset:1496
    ds_read_b128 v[116:119], v4 offset:14304
    v_mfma_f32_16x16x32_bf16 v[148:151], v[88:91], v[132:135], v[148:151]
    ds_read_b64_tr_b16 v[76:77], v11 offset:2016
    ds_read_b64_tr_b16 v[78:79], v11 offset:2008
    v_mfma_f32_16x16x32_bf16 v[148:151], v[84:87], v[136:139], v[148:151]
    s_waitcnt lgkmcnt(0)
    v_mfma_f32_16x16x32_bf16 v[152:155], v[72:75], v[104:107], 0
    ds_read_b128 v[124:127], v4 offset:12832
    ds_read_b64_tr_b16 v[84:85], v11 offset:416
    v_mfma_f32_16x16x32_bf16 v[156:159], v[76:79], v[104:107], 0
    ds_read_b64_tr_b16 v[86:87], v11 offset:408
    ds_read_b128 v[128:131], v4 offset:13344
    v_mfma_f32_16x16x32_bf16 v[152:155], v[68:71], v[108:111], v[152:155]
    ds_read_b64_tr_b16 v[88:89], v11 offset:928
    ds_read_b64_tr_b16 v[90:91], v11 offset:920
    v_mfma_f32_16x16x32_bf16 v[156:159], v[72:75], v[108:111], v[156:159]
    ds_read_b128 v[132:135], v4 offset:13856
    ds_read_b64_tr_b16 v[92:93], v11 offset:1440
    v_mfma_f32_16x16x32_bf16 v[152:155], v[64:67], v[112:115], v[152:155]
    ds_read_b64_tr_b16 v[94:95], v11 offset:1432
    ds_read_b128 v[136:139], v4 offset:14368
    v_mfma_f32_16x16x32_bf16 v[156:159], v[68:71], v[112:115], v[156:159]
    ds_read_b64_tr_b16 v[96:97], v11 offset:1952
    ds_read_b64_tr_b16 v[98:99], v11 offset:1944
    v_mfma_f32_16x16x32_bf16 v[156:159], v[64:67], v[116:119], v[156:159]
    s_waitcnt lgkmcnt(0)
    v_mfma_f32_16x16x32_bf16 v[152:155], v[92:95], v[124:127], v[152:155]
    ds_read_b128 v[104:107], v4 offset:12896
    ds_read_b64_tr_b16 v[64:65], v11 offset:352
    v_cvt_pk_bf16_f32 v144, 0, v144
    v_cvt_pk_bf16_f32 v145, 0, v145
    v_mfma_f32_16x16x32_bf16 v[156:159], v[96:99], v[124:127], v[156:159]
    ds_read_b64_tr_b16 v[66:67], v11 offset:344
    ds_read_b128 v[108:111], v4 offset:13408
    v_cvt_pk_bf16_f32 v146, 0, v146
    v_cvt_pk_bf16_f32 v147, 0, v147
    v_mfma_f32_16x16x32_bf16 v[152:155], v[88:91], v[128:131], v[152:155]
    ds_read_b64_tr_b16 v[68:69], v11 offset:864
    ds_read_b64_tr_b16 v[70:71], v11 offset:856
    v_add_f32 v144, v144, v32
    v_add_f32 v145, v145, v33
    v_mfma_f32_16x16x32_bf16 v[156:159], v[92:95], v[128:131], v[156:159]
    ds_read_b128 v[112:115], v4 offset:13920
    ds_read_b64_tr_b16 v[72:73], v11 offset:1376
    v_add_f32 v146, v146, v34
    v_add_f32 v147, v147, v35
    v_mfma_f32_16x16x32_bf16 v[152:155], v[84:87], v[132:135], v[152:155]
    ds_read_b64_tr_b16 v[74:75], v11 offset:1368
    ds_read_b128 v[116:119], v4 offset:14432
    v_cvt_pk_bf16_f32 v168, v144, v145
    v_cvt_pk_bf16_f32 v169, v146, v147
    v_mfma_f32_16x16x32_bf16 v[156:159], v[88:91], v[132:135], v[156:159]
    ds_read_b64_tr_b16 v[76:77], v11 offset:1888
    ds_read_b64_tr_b16 v[78:79], v11 offset:1880
    v_cvt_pk_bf16_f32 v148, 0, v148
    v_cvt_pk_bf16_f32 v149, 0, v149
    v_mfma_f32_16x16x32_bf16 v[156:159], v[84:87], v[136:139], v[156:159]
    v_cvt_pk_bf16_f32 v150, 0, v150
    v_cvt_pk_bf16_f32 v151, 0, v151
    s_waitcnt lgkmcnt(0)
    v_mfma_f32_16x16x32_bf16 v[152:155], v[72:75], v[104:107], v[152:155]
    ds_read_b128 v[124:127], v4 offset:12960
    ds_read_b64_tr_b16 v[84:85], v11 offset:288
    v_add_f32 v148, v148, v36
    v_add_f32 v149, v149, v37
    v_mfma_f32_16x16x32_bf16 v[156:159], v[76:79], v[104:107], v[156:159]
    ds_read_b64_tr_b16 v[86:87], v11 offset:280
    ds_read_b128 v[128:131], v4 offset:13472
    v_add_f32 v150, v150, v38
    v_add_f32 v151, v151, v39
    v_mfma_f32_16x16x32_bf16 v[152:155], v[68:71], v[108:111], v[152:155]
    ds_read_b64_tr_b16 v[88:89], v11 offset:800
    ds_read_b64_tr_b16 v[90:91], v11 offset:792
    v_cvt_pk_bf16_f32 v170, v148, v149
    v_cvt_pk_bf16_f32 v171, v150, v151
    v_mfma_f32_16x16x32_bf16 v[156:159], v[72:75], v[108:111], v[156:159]
    ds_read_b128 v[132:135], v4 offset:13984
    ds_read_b64_tr_b16 v[92:93], v11 offset:1312
    v_permlane16_swap_b32 v168, v170
    v_permlane16_swap_b32 v169, v171
    v_mfma_f32_16x16x32_bf16 v[152:155], v[64:67], v[112:115], v[152:155]
    ds_read_b64_tr_b16 v[94:95], v11 offset:1304
    ds_read_b128 v[136:139], v4 offset:14496
    buffer_store_dwordx4 v[168:171], v0, s[56:59], s9 offen offset:1024 sc1
    s_add_u32 s9, s9, 4096
    v_mfma_f32_16x16x32_bf16 v[156:159], v[68:71], v[112:115], v[156:159]
    ds_read_b64_tr_b16 v[96:97], v11 offset:1824
    ds_read_b64_tr_b16 v[98:99], v11 offset:1816
    v_lshlrev_b32 v48, 16, v28
    v_and_b32 v49, s12, v28
    v_mfma_f32_16x16x32_bf16 v[156:159], v[64:67], v[116:119], v[156:159]
    v_lshlrev_b32 v50, 16, v29
    v_and_b32 v51, s12, v29
    s_waitcnt lgkmcnt(0)
    v_mfma_f32_16x16x32_bf16 v[152:155], v[92:95], v[124:127], v[152:155]
    ds_read_b128 v[104:107], v4 offset:13024
    ds_read_b64_tr_b16 v[64:65], v11 offset:224
    v_mul_f32 v48, v10, v48
    v_mul_f32 v49, v10, v49
    v_mfma_f32_16x16x32_bf16 v[156:159], v[96:99], v[124:127], v[156:159]
    ds_read_b64_tr_b16 v[66:67], v11 offset:216
    ds_read_b128 v[108:111], v4 offset:13536
    v_mul_f32 v50, v10, v50
    v_mul_f32 v51, v10, v51
    v_mfma_f32_16x16x32_bf16 v[152:155], v[88:91], v[128:131], v[152:155]
    ds_read_b64_tr_b16 v[68:69], v11 offset:736
    ds_read_b64_tr_b16 v[70:71], v11 offset:728
    v_cvt_pk_bf16_f32 v48, 0, v48
    v_cvt_pk_bf16_f32 v49, 0, v49
    v_mfma_f32_16x16x32_bf16 v[156:159], v[92:95], v[128:131], v[156:159]
    ds_read_b128 v[112:115], v4 offset:14048
    ds_read_b64_tr_b16 v[72:73], v11 offset:1248
    v_cvt_pk_bf16_f32 v50, 0, v50
    v_cvt_pk_bf16_f32 v51, 0, v51
    v_mfma_f32_16x16x32_bf16 v[152:155], v[84:87], v[132:135], v[152:155]
    ds_read_b64_tr_b16 v[74:75], v11 offset:1240
    ds_read_b128 v[116:119], v4 offset:14560
    v_lshlrev_b32 v52, 16, v30
    v_and_b32 v53, s12, v30
    v_mfma_f32_16x16x32_bf16 v[156:159], v[88:91], v[132:135], v[156:159]
    ds_read_b64_tr_b16 v[76:77], v11 offset:1760
    ds_read_b64_tr_b16 v[78:79], v11 offset:1752
    v_lshlrev_b32 v54, 16, v31
    v_and_b32 v55, s12, v31
    v_mfma_f32_16x16x32_bf16 v[156:159], v[84:87], v[136:139], v[156:159]
    v_mul_f32 v52, v10, v52
    v_mul_f32 v53, v10, v53
    s_waitcnt lgkmcnt(0)
    v_mfma_f32_16x16x32_bf16 v[152:155], v[72:75], v[104:107], v[152:155]
    ds_read_b128 v[124:127], v4 offset:13088
    ds_read_b64_tr_b16 v[84:85], v11 offset:160
    v_mul_f32 v54, v10, v54
    v_mul_f32 v55, v10, v55
    v_mfma_f32_16x16x32_bf16 v[156:159], v[76:79], v[104:107], v[156:159]
    ds_read_b64_tr_b16 v[86:87], v11 offset:152
    ds_read_b128 v[128:131], v4 offset:13600
    v_cvt_pk_bf16_f32 v52, 0, v52
    v_cvt_pk_bf16_f32 v53, 0, v53
    v_mfma_f32_16x16x32_bf16 v[152:155], v[68:71], v[108:111], v[152:155]
    ds_read_b64_tr_b16 v[88:89], v11 offset:672
    ds_read_b64_tr_b16 v[90:91], v11 offset:664
    v_cvt_pk_bf16_f32 v54, 0, v54
    v_cvt_pk_bf16_f32 v55, 0, v55
    v_mfma_f32_16x16x32_bf16 v[156:159], v[72:75], v[108:111], v[156:159]
    ds_read_b128 v[132:135], v4 offset:14112
    ds_read_b64_tr_b16 v[92:93], v11 offset:1184
    v_mfma_f32_16x16x32_bf16 v[152:155], v[64:67], v[112:115], v[152:155]
    ds_read_b64_tr_b16 v[94:95], v11 offset:1176
    ds_read_b128 v[136:139], v4 offset:14624
    v_mfma_f32_16x16x32_bf16 v[156:159], v[68:71], v[112:115], v[156:159]
    ds_read_b64_tr_b16 v[96:97], v11 offset:1696
    ds_read_b64_tr_b16 v[98:99], v11 offset:1688
    v_mfma_f32_16x16x32_bf16 v[156:159], v[64:67], v[116:119], v[156:159]
    s_waitcnt lgkmcnt(0)
    v_mfma_f32_16x16x32_bf16 v[152:155], v[92:95], v[124:127], v[152:155]
    ds_read_b128 v[104:107], v4 offset:13152
    ds_read_b64_tr_b16 v[64:65], v11 offset:96
    v_mfma_f32_16x16x32_bf16 v[156:159], v[96:99], v[124:127], v[156:159]
    ds_read_b64_tr_b16 v[66:67], v11 offset:88
    ds_read_b128 v[108:111], v4 offset:13664
    v_mfma_f32_16x16x32_bf16 v[152:155], v[88:91], v[128:131], v[152:155]
    ds_read_b64_tr_b16 v[68:69], v11 offset:608
    ds_read_b64_tr_b16 v[70:71], v11 offset:600
    v_mfma_f32_16x16x32_bf16 v[156:159], v[92:95], v[128:131], v[156:159]
    ds_read_b128 v[112:115], v4 offset:14176
    ds_read_b64_tr_b16 v[72:73], v11 offset:1120
    v_mfma_f32_16x16x32_bf16 v[152:155], v[84:87], v[132:135], v[152:155]
    ds_read_b64_tr_b16 v[74:75], v11 offset:1112
    ds_read_b128 v[116:119], v4 offset:14688
    v_mfma_f32_16x16x32_bf16 v[156:159], v[88:91], v[132:135], v[156:159]
    ds_read_b64_tr_b16 v[76:77], v11 offset:1632
    ds_read_b64_tr_b16 v[78:79], v11 offset:1624
    v_mfma_f32_16x16x32_bf16 v[156:159], v[84:87], v[136:139], v[156:159]
    s_waitcnt lgkmcnt(0)
    v_mfma_f32_16x16x32_bf16 v[152:155], v[72:75], v[104:107], v[152:155]
    ds_read_b128 v[124:127], v4 offset:13216
    ds_read_b64_tr_b16 v[84:85], v11 offset:32
    v_mfma_f32_16x16x32_bf16 v[156:159], v[76:79], v[104:107], v[156:159]
    ds_read_b64_tr_b16 v[86:87], v11 offset:24
    ds_read_b128 v[128:131], v4 offset:13728
    v_mfma_f32_16x16x32_bf16 v[152:155], v[68:71], v[108:111], v[152:155]
    ds_read_b64_tr_b16 v[88:89], v11 offset:544
    ds_read_b64_tr_b16 v[90:91], v11 offset:536
    v_mfma_f32_16x16x32_bf16 v[156:159], v[72:75], v[108:111], v[156:159]
    ds_read_b128 v[132:135], v4 offset:14240
    ds_read_b64_tr_b16 v[92:93], v11 offset:1056
    v_mfma_f32_16x16x32_bf16 v[152:155], v[64:67], v[112:115], v[152:155]
    ds_read_b64_tr_b16 v[94:95], v11 offset:1048
    ds_read_b128 v[136:139], v4 offset:14752
    v_mfma_f32_16x16x32_bf16 v[156:159], v[68:71], v[112:115], v[156:159]
    ds_read_b64_tr_b16 v[96:97], v11 offset:1568
    ds_read_b64_tr_b16 v[98:99], v11 offset:1560
    v_mfma_f32_16x16x32_bf16 v[156:159], v[64:67], v[116:119], v[156:159]
    s_waitcnt lgkmcnt(0)
    v_mfma_f32_16x16x32_bf16 v[152:155], v[92:95], v[124:127], v[152:155]
    ds_read_b128 v[104:107], v4 offset:25536
    ds_read_b64_tr_b16 v[64:65], v16 offset:480
    v_mfma_f32_16x16x32_bf16 v[156:159], v[96:99], v[124:127], v[156:159]
    ds_read_b64_tr_b16 v[66:67], v16 offset:472
    ds_read_b128 v[108:111], v4 offset:26048
    v_mfma_f32_16x16x32_bf16 v[152:155], v[88:91], v[128:131], v[152:155]
    ds_read_b64_tr_b16 v[68:69], v16 offset:992
    ds_read_b64_tr_b16 v[70:71], v16 offset:984
    v_mfma_f32_16x16x32_bf16 v[156:159], v[92:95], v[128:131], v[156:159]
    ds_read_b128 v[112:115], v4 offset:26560
    ds_read_b64_tr_b16 v[72:73], v16 offset:1504
    v_mfma_f32_16x16x32_bf16 v[152:155], v[84:87], v[132:135], v[152:155]
    ds_read_b64_tr_b16 v[74:75], v16 offset:1496
    ds_read_b128 v[116:119], v4 offset:27072
    v_mfma_f32_16x16x32_bf16 v[156:159], v[88:91], v[132:135], v[156:159]
    ds_read_b64_tr_b16 v[76:77], v16 offset:2016
    ds_read_b64_tr_b16 v[78:79], v16 offset:2008
    v_mfma_f32_16x16x32_bf16 v[156:159], v[84:87], v[136:139], v[156:159]
    s_cmp_eq_u32 s7, 2
    s_cbranch_scc1 LW3e
    s_waitcnt lgkmcnt(0)
    v_mfma_f32_16x16x32_bf16 v[160:163], v[72:75], v[104:107], 0
    ds_read_b128 v[124:127], v4 offset:25600
    ds_read_b64_tr_b16 v[84:85], v16 offset:416
    v_mfma_f32_16x16x32_bf16 v[164:167], v[76:79], v[104:107], 0
    ds_read_b64_tr_b16 v[86:87], v16 offset:408
    ds_read_b128 v[128:131], v4 offset:26112
    v_mfma_f32_16x16x32_bf16 v[160:163], v[68:71], v[108:111], v[160:163]
    ds_read_b64_tr_b16 v[88:89], v16 offset:928
    ds_read_b64_tr_b16 v[90:91], v16 offset:920
    v_mfma_f32_16x16x32_bf16 v[164:167], v[72:75], v[108:111], v[164:167]
    ds_read_b128 v[132:135], v4 offset:26624
    ds_read_b64_tr_b16 v[92:93], v16 offset:1440
    v_mfma_f32_16x16x32_bf16 v[160:163], v[64:67], v[112:115], v[160:163]
    ds_read_b64_tr_b16 v[94:95], v16 offset:1432
    ds_read_b128 v[136:139], v4 offset:27136
    v_mfma_f32_16x16x32_bf16 v[164:167], v[68:71], v[112:115], v[164:167]
    ds_read_b64_tr_b16 v[96:97], v16 offset:1952
    ds_read_b64_tr_b16 v[98:99], v16 offset:1944
    v_mfma_f32_16x16x32_bf16 v[164:167], v[64:67], v[116:119], v[164:167]
    s_waitcnt lgkmcnt(0)
    v_mfma_f32_16x16x32_bf16 v[160:163], v[92:95], v[124:127], v[160:163]
    ds_read_b128 v[104:107], v4 offset:25664
    ds_read_b64_tr_b16 v[64:65], v16 offset:352
    v_cvt_pk_bf16_f32 v152, 0, v152
    v_cvt_pk_bf16_f32 v153, 0, v153
    v_mfma_f32_16x16x32_bf16 v[164:167], v[96:99], v[124:127], v[164:167]
    ds_read_b64_tr_b16 v[66:67], v16 offset:344
    ds_read_b128 v[108:111], v4 offset:26176
    v_cvt_pk_bf16_f32 v154, 0, v154
    v_cvt_pk_bf16_f32 v155, 0, v155
    v_mfma_f32_16x16x32_bf16 v[160:163], v[88:91], v[128:131], v[160:163]
    ds_read_b64_tr_b16 v[68:69], v16 offset:864
    ds_read_b64_tr_b16 v[70:71], v16 offset:856
    v_add_f32 v152, v152, v40
    v_add_f32 v153, v153, v41
    v_mfma_f32_16x16x32_bf16 v[164:167], v[92:95], v[128:131], v[164:167]
    ds_read_b128 v[112:115], v4 offset:26688
    ds_read_b64_tr_b16 v[72:73], v16 offset:1376
    v_add_f32 v154, v154, v42
    v_add_f32 v155, v155, v43
    v_mfma_f32_16x16x32_bf16 v[160:163], v[84:87], v[132:135], v[160:163]
    ds_read_b64_tr_b16 v[74:75], v16 offset:1368
    ds_read_b128 v[116:119], v4 offset:27200
    v_cvt_pk_bf16_f32 v172, v152, v153
    v_cvt_pk_bf16_f32 v173, v154, v155
    v_mfma_f32_16x16x32_bf16 v[164:167], v[88:91], v[132:135], v[164:167]
    ds_read_b64_tr_b16 v[76:77], v16 offset:1888
    ds_read_b64_tr_b16 v[78:79], v16 offset:1880
    v_cvt_pk_bf16_f32 v156, 0, v156
    v_cvt_pk_bf16_f32 v157, 0, v157
    v_mfma_f32_16x16x32_bf16 v[164:167], v[84:87], v[136:139], v[164:167]
    v_cvt_pk_bf16_f32 v158, 0, v158
    v_cvt_pk_bf16_f32 v159, 0, v159
    s_waitcnt lgkmcnt(0)
    v_mfma_f32_16x16x32_bf16 v[160:163], v[72:75], v[104:107], v[160:163]
    ds_read_b128 v[124:127], v4 offset:25728
    ds_read_b64_tr_b16 v[84:85], v16 offset:288
    v_add_f32 v156, v156, v44
    v_add_f32 v157, v157, v45
    v_mfma_f32_16x16x32_bf16 v[164:167], v[76:79], v[104:107], v[164:167]
    ds_read_b64_tr_b16 v[86:87], v16 offset:280
    ds_read_b128 v[128:131], v4 offset:26240
    v_add_f32 v158, v158, v46
    v_add_f32 v159, v159, v47
    v_mfma_f32_16x16x32_bf16 v[160:163], v[68:71], v[108:111], v[160:163]
    ds_read_b64_tr_b16 v[88:89], v16 offset:800
    ds_read_b64_tr_b16 v[90:91], v16 offset:792
    v_cvt_pk_bf16_f32 v174, v156, v157
    v_cvt_pk_bf16_f32 v175, v158, v159
    v_mfma_f32_16x16x32_bf16 v[164:167], v[72:75], v[108:111], v[164:167]
    ds_read_b128 v[132:135], v4 offset:26752
    ds_read_b64_tr_b16 v[92:93], v16 offset:1312
    v_permlane16_swap_b32 v172, v174
    v_permlane16_swap_b32 v173, v175
    v_mfma_f32_16x16x32_bf16 v[160:163], v[64:67], v[112:115], v[160:163]
    ds_read_b64_tr_b16 v[94:95], v16 offset:1304
    ds_read_b128 v[136:139], v4 offset:27264
    buffer_store_dwordx4 v[172:175], v0, s[56:59], s9 offen offset:1024 sc1
    s_add_u32 s9, s9, 4096
    v_mfma_f32_16x16x32_bf16 v[164:167], v[68:71], v[112:115], v[164:167]
    ds_read_b64_tr_b16 v[96:97], v16 offset:1824
    ds_read_b64_tr_b16 v[98:99], v16 offset:1816
    v_mfma_f32_16x16x32_bf16 v[164:167], v[64:67], v[116:119], v[164:167]
    s_waitcnt lgkmcnt(0)
    v_mfma_f32_16x16x32_bf16 v[160:163], v[92:95], v[124:127], v[160:163]
    ds_read_b128 v[104:107], v4 offset:25792
    ds_read_b64_tr_b16 v[64:65], v16 offset:224
    v_mfma_f32_16x16x32_bf16 v[164:167], v[96:99], v[124:127], v[164:167]
    ds_read_b64_tr_b16 v[66:67], v16 offset:216
    ds_read_b128 v[108:111], v4 offset:26304
    v_mfma_f32_16x16x32_bf16 v[160:163], v[88:91], v[128:131], v[160:163]
    ds_read_b64_tr_b16 v[68:69], v16 offset:736
    ds_read_b64_tr_b16 v[70:71], v16 offset:728
    v_mfma_f32_16x16x32_bf16 v[164:167], v[92:95], v[128:131], v[164:167]
    ds_read_b128 v[112:115], v4 offset:26816
    ds_read_b64_tr_b16 v[72:73], v16 offset:1248
    v_mfma_f32_16x16x32_bf16 v[160:163], v[84:87], v[132:135], v[160:163]
    ds_read_b64_tr_b16 v[74:75], v16 offset:1240
    ds_read_b128 v[116:119], v4 offset:27328
    v_mfma_f32_16x16x32_bf16 v[164:167], v[88:91], v[132:135], v[164:167]
    ds_read_b64_tr_b16 v[76:77], v16 offset:1760
    ds_read_b64_tr_b16 v[78:79], v16 offset:1752
    v_mfma_f32_16x16x32_bf16 v[164:167], v[84:87], v[136:139], v[164:167]
    s_waitcnt lgkmcnt(0)
    v_mfma_f32_16x16x32_bf16 v[160:163], v[72:75], v[104:107], v[160:163]
    ds_read_b128 v[124:127], v4 offset:25856
    ds_read_b64_tr_b16 v[84:85], v16 offset:160
    v_mfma_f32_16x16x32_bf16 v[164:167], v[76:79], v[104:107], v[164:167]
    ds_read_b64_tr_b16 v[86:87], v16 offset:152
    ds_read_b128 v[128:131], v4 offset:26368
    v_mfma_f32_16x16x32_bf16 v[160:163], v[68:71], v[108:111], v[160:163]
    ds_read_b64_tr_b16 v[88:89], v16 offset:672
    ds_read_b64_tr_b16 v[90:91], v16 offset:664
    v_mfma_f32_16x16x32_bf16 v[164:167], v[72:75], v[108:111], v[164:167]
    ds_read_b128 v[132:135], v4 offset:26880
    ds_read_b64_tr_b16 v[92:93], v16 offset:1184
    v_mfma_f32_16x16x32_bf16 v[160:163], v[64:67], v[112:115], v[160:163]
    ds_read_b64_tr_b16 v[94:95], v16 offset:1176
    ds_read_b128 v[136:139], v4 offset:27392
    v_mfma_f32_16x16x32_bf16 v[164:167], v[68:71], v[112:115], v[164:167]
    ds_read_b64_tr_b16 v[96:97], v16 offset:1696
    ds_read_b64_tr_b16 v[98:99], v16 offset:1688
    v_mfma_f32_16x16x32_bf16 v[164:167], v[64:67], v[116:119], v[164:167]
    s_waitcnt lgkmcnt(0)
    v_mfma_f32_16x16x32_bf16 v[160:163], v[92:95], v[124:127], v[160:163]
    ds_read_b128 v[104:107], v4 offset:25920
    ds_read_b64_tr_b16 v[64:65], v16 offset:96
    v_mfma_f32_16x16x32_bf16 v[164:167], v[96:99], v[124:127], v[164:167]
    ds_read_b64_tr_b16 v[66:67], v16 offset:88
    ds_read_b128 v[108:111], v4 offset:26432
    v_mfma_f32_16x16x32_bf16 v[160:163], v[88:91], v[128:131], v[160:163]
    ds_read_b64_tr_b16 v[68:69], v16 offset:608
    ds_read_b64_tr_b16 v[70:71], v16 offset:600
    v_mfma_f32_16x16x32_bf16 v[164:167], v[92:95], v[128:131], v[164:167]
    ds_read_b128 v[112:115], v4 offset:26944
    ds_read_b64_tr_b16 v[72:73], v16 offset:1120
    v_mfma_f32_16x16x32_bf16 v[160:163], v[84:87], v[132:135], v[160:163]
    ds_read_b64_tr_b16 v[74:75], v16 offset:1112
    ds_read_b128 v[116:119], v4 offset:27456
    v_mfma_f32_16x16x32_bf16 v[164:167], v[88:91], v[132:135], v[164:167]
    ds_read_b64_tr_b16 v[76:77], v16 offset:1632
    ds_read_b64_tr_b16 v[78:79], v16 offset:1624
    v_mfma_f32_16x16x32_bf16 v[164:167], v[84:87], v[136:139], v[164:167]
    s_waitcnt lgkmcnt(0)
    v_mfma_f32_16x16x32_bf16 v[160:163], v[72:75], v[104:107], v[160:163]
    ds_read_b128 v[124:127], v4 offset:25984
    ds_read_b64_tr_b16 v[84:85], v16 offset:32
    v_mfma_f32_16x16x32_bf16 v[164:167], v[76:79], v[104:107], v[164:167]
    ds_read_b64_tr_b16 v[86:87], v16 offset:24
    ds_read_b128 v[128:131], v4 offset:26496
    v_mfma_f32_16x16x32_bf16 v[160:163], v[68:71], v[108:111], v[160:163]
    ds_read_b64_tr_b16 v[88:89], v16 offset:544
    ds_read_b64_tr_b16 v[90:91], v16 offset:536
    v_mfma_f32_16x16x32_bf16 v[164:167], v[72:75], v[108:111], v[164:167]
    ds_read_b128 v[132:135], v4 offset:27008
    ds_read_b64_tr_b16 v[92:93], v16 offset:1056
    v_mfma_f32_16x16x32_bf16 v[160:163], v[64:67], v[112:115], v[160:163]
    ds_read_b64_tr_b16 v[94:95], v16 offset:1048
    ds_read_b128 v[136:139], v4 offset:27520
    v_mfma_f32_16x16x32_bf16 v[164:167], v[68:71], v[112:115], v[164:167]
    ds_read_b64_tr_b16 v[96:97], v16 offset:1568
    ds_read_b64_tr_b16 v[98:99], v16 offset:1560
    v_mfma_f32_16x16x32_bf16 v[164:167], v[64:67], v[116:119], v[164:167]
    s_waitcnt lgkmcnt(0)
    v_mfma_f32_16x16x32_bf16 v[160:163], v[92:95], v[124:127], v[160:163]
    v_mfma_f32_16x16x32_bf16 v[164:167], v[96:99], v[124:127], v[164:167]
    v_mfma_f32_16x16x32_bf16 v[160:163], v[88:91], v[128:131], v[160:163]
    v_mfma_f32_16x16x32_bf16 v[164:167], v[92:95], v[128:131], v[164:167]
    v_mfma_f32_16x16x32_bf16 v[160:163], v[84:87], v[132:135], v[160:163]
    v_mfma_f32_16x16x32_bf16 v[164:167], v[88:91], v[132:135], v[164:167]
    v_mfma_f32_16x16x32_bf16 v[164:167], v[84:87], v[136:139], v[164:167]
    s_nop 5
    v_cvt_pk_bf16_f32 v160, 0, v160
    v_cvt_pk_bf16_f32 v161, 0, v161
    v_cvt_pk_bf16_f32 v162, 0, v162
    v_cvt_pk_bf16_f32 v163, 0, v163
    v_add_f32 v160, v160, v48
    v_add_f32 v161, v161, v49
    v_add_f32 v162, v162, v50
    v_add_f32 v163, v163, v51
    v_cvt_pk_bf16_f32 v176, v160, v161
    v_cvt_pk_bf16_f32 v177, v162, v163
    v_cvt_pk_bf16_f32 v164, 0, v164
    v_cvt_pk_bf16_f32 v165, 0, v165
    v_cvt_pk_bf16_f32 v166, 0, v166
    v_cvt_pk_bf16_f32 v167, 0, v167
    v_add_f32 v164, v164, v52
    v_add_f32 v165, v165, v53
    v_add_f32 v166, v166, v54
    v_add_f32 v167, v167, v55
    v_cvt_pk_bf16_f32 v178, v164, v165
    v_cvt_pk_bf16_f32 v179, v166, v167
    s_nop 0
    v_permlane16_swap_b32 v176, v178
    v_permlane16_swap_b32 v177, v179
    buffer_store_dwordx4 v[176:179], v0, s[56:59], s9 offen offset:1024 sc1
    s_add_u32 s9, s9, 4096
    s_branch LW3f
LW3e:
    s_waitcnt lgkmcnt(0)
    s_nop 7
    v_cvt_pk_bf16_f32 v152, 0, v152
    v_cvt_pk_bf16_f32 v153, 0, v153
    v_cvt_pk_bf16_f32 v154, 0, v154
    v_cvt_pk_bf16_f32 v155, 0, v155
    v_add_f32 v152, v152, v40
    v_add_f32 v153, v153, v41
    v_add_f32 v154, v154, v42
    v_add_f32 v155, v155, v43
    v_cvt_pk_bf16_f32 v172, v152, v153
    v_cvt_pk_bf16_f32 v173, v154, v155
    v_cvt_pk_bf16_f32 v156, 0, v156
    v_cvt_pk_bf16_f32 v157, 0, v157
    v_cvt_pk_bf16_f32 v158, 0, v158
    v_cvt_pk_bf16_f32 v159, 0, v159
    v_add_f32 v156, v156, v44
    v_add_f32 v157, v157, v45
    v_add_f32 v158, v158, v46
    v_add_f32 v159, v159, v47
    v_cvt_pk_bf16_f32 v174, v156, v157
    v_cvt_pk_bf16_f32 v175, v158, v159
    s_nop 0
    v_permlane16_swap_b32 v172, v174
    v_permlane16_swap_b32 v173, v175
    buffer_store_dwordx4 v[172:175], v0, s[56:59], s9 offen offset:1024 sc1
    s_add_u32 s9, s9, 4096
LW3f:
    s_lshl_b32 s9, s6, 2
    s_add_u32 s9, s9, 283648
    v_mov_b32 v8, s4
    v_and_b32 v9, 7, v1
    v_mul_u32_u24 v9, 2688, v9
    v_lshrrev_b32 v10, 3, v1
    v_lshl_add_u32 v9, v10, 2, v9
    s_lshl_b32 s7, s7, 3
    s_bfm_b64 s[10:11], s7, 0
    s_waitcnt vmcnt(0)
    s_mov_b64 exec, s[10:11]
    buffer_store_dword v8, v9, s[56:59], s9 offen sc1
    s_mov_b64 exec, -1
    s_endpgm
LAUX:
    s_cmp_eq_u32 s5, 255
    s_cbranch_scc1 LUPD
    s_lshl_b32 s8, s68, 4
    s_add_u32 s8, s8, s69
    s_sub_u32 s8, s8, 16
    s_cmp_ge_u32 s8, 120
    s_cbranch_scc1 Lexit
    s_setprio 3
    s_mul_i32 s9, s8, 5462
    s_lshr_b32 s9, s9, 16
    s_mul_i32 s10, s9, 12
    s_sub_u32 s10, s8, s10
    v_lshrrev_b32 v2, 3, v1
    v_mul_u32_u24 v2, 1280, v2
    v_and_b32 v3, 7, v1
    v_lshl_add_u32 v2, v3, 4, v2
    s_mul_i32 s11, s10, 163840
    s_lshl_b32 s12, s9, 7
    s_add_u32 s11, s11, s12
    v_bfe_u32 v3, v1, 4, 1
    v_lshlrev_b32 v3, 4, v3
    v_lshrrev_b32 v4, 5, v1
    v_lshl_add_u32 v3, v4, 2, v3
    v_bfe_u32 v4, v1, 2, 2
    v_add_u32 v3, v3, v4
    v_lshlrev_b32 v3, 7, v3
    v_and_b32 v4, 3, v1
    v_lshl_add_u32 v3, v4, 3, v3
    v_add_u32 v4, 63264, v3
    v_add_u32 v3, 25536, v3
    s_waitcnt lgkmcnt(0)
    s_mov_b32 s52, s38
    s_mov_b32 s53, s39
    s_mov_b32 s54, 1966080
    s_mov_b32 s55, 0x20000
    s_mov_b32 m0, 25536
    s_nop 0
    buffer_load_dwordx4 v2, s[52:55], s11 offen nt lds
    s_add_u32 s11, s11, 10240
    s_mov_b32 m0, 26560
    s_nop 0
    buffer_load_dwordx4 v2, s[52:55], s11 offen nt lds
    s_add_u32 s11, s11, 10240
    s_mov_b32 m0, 27584
    s_nop 0
    buffer_load_dwordx4 v2, s[52:55], s11 offen nt lds
    s_add_u32 s11, s11, 10240
    s_mov_b32 m0, 28608
    s_nop 0
    buffer_load_dwordx4 v2, s[52:55], s11 offen nt lds
    s_add_u32 s11, s11, 10240
    s_mov_b32 m0, 29632
    s_nop 0
    buffer_load_dwordx4 v2, s[52:55], s11 offen nt lds
    s_add_u32 s11, s11, 10240
    s_mov_b32 m0, 30656
    s_nop 0
    buffer_load_dwordx4 v2, s[52:55], s11 offen nt lds
    s_add_u32 s11, s11, 10240
    s_mov_b32 m0, 31680
    s_nop 0
    buffer_load_dwordx4 v2, s[52:55], s11 offen nt lds
    s_add_u32 s11, s11, 10240
    s_mov_b32 m0, 32704
    s_nop 0
    buffer_load_dwordx4 v2, s[52:55], s11 offen nt lds
    s_add_u32 s11, s11, 10240
    s_mov_b32 m0, 63264
    s_nop 0
    buffer_load_dwordx4 v2, s[52:55], s11 offen nt lds
    s_add_u32 s11, s11, 10240
    s_mov_b32 m0, 64288
    s_nop 0
    buffer_load_dwordx4 v2, s[52:55], s11 offen nt lds
    s_add_u32 s11, s11, 10240
    s_mov_b32 m0, 65312
    s_nop 0
    buffer_load_dwordx4 v2, s[52:55], s11 offen nt lds
    s_add_u32 s11, s11, 10240
    s_mov_b32 m0, 66336
    s_nop 0
    buffer_load_dwordx4 v2, s[52:55], s11 offen nt lds
    s_add_u32 s11, s11, 10240
    s_mov_b32 m0, 67360
    s_nop 0
    buffer_load_dwordx4 v2, s[52:55], s11 offen nt lds
    s_add_u32 s11, s11, 10240
    s_mov_b32 m0, 68384
    s_nop 0
    buffer_load_dwordx4 v2, s[52:55], s11 offen nt lds
    s_add_u32 s11, s11, 10240
    s_mov_b32 m0, 69408
    s_nop 0
    buffer_load_dwordx4 v2, s[52:55], s11 offen nt lds
    s_add_u32 s11, s11, 10240
    s_mov_b32 m0, 70432
    s_nop 0
    buffer_load_dwordx4 v2, s[52:55], s11 offen nt lds
    s_mov_b32 s56, s46
    s_mov_b32 s57, s47
    s_mov_b32 s58, 16777216
    s_mov_b32 s59, 0x20000
    s_mov_b32 s96, s46
    s_mov_b32 s97, s47
    s_load_dword s4, s[46:47], 0
    v_lshlrev_b32 v2, 4, v1
    s_lshl_b32 s12, s9, 2
    s_add_u32 s12, s12, 0
    s_mul_i32 s13, s12, 205
    s_lshr_b32 s13, s13, 10
    s_mul_i32 s14, s13, 235
    s_add_u32 s12, s12, s14
    s_mul_i32 s14, s10, 20
    s_add_u32 s12, s12, s14
    s_lshl_b32 s12, s12, 10
    s_add_u32 s72, s12, 1048576
    s_lshl_b32 s12, s9, 2
    s_add_u32 s12, s12, 1
    s_mul_i32 s13, s12, 205
    s_lshr_b32 s13, s13, 10
    s_mul_i32 s14, s13, 235
    s_add_u32 s12, s12, s14
    s_mul_i32 s14, s10, 20
    s_add_u32 s12, s12, s14
    s_lshl_b32 s12, s12, 10
    s_add_u32 s73, s12, 1048576
    s_lshl_b32 s12, s9, 2
    s_add_u32 s12, s12, 2
    s_mul_i32 s13, s12, 205
    s_lshr_b32 s13, s13, 10
    s_mul_i32 s14, s13, 235
    s_add_u32 s12, s12, s14
    s_mul_i32 s14, s10, 20
    s_add_u32 s12, s12, s14
    s_lshl_b32 s12, s12, 10
    s_add_u32 s74, s12, 1048576
    s_lshl_b32 s12, s9, 2
    s_add_u32 s12, s12, 3
    s_mul_i32 s13, s12, 205
    s_lshr_b32 s13, s13, 10
    s_mul_i32 s14, s13, 235
    s_add_u32 s12, s12, s14
    s_mul_i32 s14, s10, 20
    s_add_u32 s12, s12, s14
    s_lshl_b32 s12, s12, 10
    s_add_u32 s75, s12, 1048576
    s_mul_i32 s12, s10, 22
    s_lshr_b32 s12, s12, 6
    s_mul_i32 s12, s12, 5
    s_add_u32 s12, s12, s10
    s_cmp_ge_u32 s9, 5
    s_cselect_b32 s13, 1, 0
    s_sub_u32 s14, s9, s13
    s_mul_i32 s13, s13, 5
    s_sub_u32 s76, s9, s13
    s_lshl_b32 s14, s14, 10
    s_add_u32 s12, s12, s14
    s_lshl_b32 s12, s12, 2
    s_add_u32 s12, s12, 28684
    v_and_b32 v5, 31, v1
    v_lshlrev_b32 v5, 7, v5
    v_cmp_gt_u32 vcc, 32, v1
    v_mov_b32 v6, 4084
    s_nop 0
    v_cndmask_b32 v6, 0, v6, vcc
    v_add_u32 v5, v5, v6
    s_waitcnt lgkmcnt(0)
    s_add_u32 s4, s4, 1
    s_waitcnt vmcnt(12)
    ds_read_b64_tr_b16 v[16:17], v3 offset:0
    ds_read_b64_tr_b16 v[18:19], v3 offset:1024
    ds_read_b64_tr_b16 v[20:21], v3 offset:32
    ds_read_b64_tr_b16 v[22:23], v3 offset:1056
    ds_read_b64_tr_b16 v[24:25], v3 offset:64
    ds_read_b64_tr_b16 v[26:27], v3 offset:1088
    ds_read_b64_tr_b16 v[28:29], v3 offset:96
    ds_read_b64_tr_b16 v[30:31], v3 offset:1120
    s_waitcnt vmcnt(8)
    ds_read_b64_tr_b16 v[32:33], v3 offset:4096
    ds_read_b64_tr_b16 v[34:35], v3 offset:5120
    ds_read_b64_tr_b16 v[36:37], v3 offset:4128
    ds_read_b64_tr_b16 v[38:39], v3 offset:5152
    ds_read_b64_tr_b16 v[40:41], v3 offset:4160
    ds_read_b64_tr_b16 v[42:43], v3 offset:5184
    ds_read_b64_tr_b16 v[44:45], v3 offset:4192
    ds_read_b64_tr_b16 v[46:47], v3 offset:5216
    s_waitcnt vmcnt(4)
    ds_read_b64_tr_b16 v[48:49], v4 offset:0
    ds_read_b64_tr_b16 v[50:51], v4 offset:1024
    ds_read_b64_tr_b16 v[52:53], v4 offset:32
    ds_read_b64_tr_b16 v[54:55], v4 offset:1056
    ds_read_b64_tr_b16 v[56:57], v4 offset:64
    ds_read_b64_tr_b16 v[58:59], v4 offset:1088
    ds_read_b64_tr_b16 v[60:61], v4 offset:96
    ds_read_b64_tr_b16 v[62:63], v4 offset:1120
    s_waitcnt vmcnt(0)
    ds_read_b64_tr_b16 v[64:65], v4 offset:4096
    ds_read_b64_tr_b16 v[66:67], v4 offset:5120
    ds_read_b64_tr_b16 v[68:69], v4 offset:4128
    ds_read_b64_tr_b16 v[70:71], v4 offset:5152
    ds_read_b64_tr_b16 v[72:73], v4 offset:4160
    ds_read_b64_tr_b16 v[74:75], v4 offset:5184
    ds_read_b64_tr_b16 v[76:77], v4 offset:4192
    ds_read_b64_tr_b16 v[78:79], v4 offset:5216
    s_waitcnt lgkmcnt(15)
    buffer_store_dwordx4 v[16:19], v2, s[56:59], s72 offen sc1
    s_add_u32 s72, s72, 5120
    s_waitcnt lgkmcnt(15)
    buffer_store_dwordx4 v[20:23], v2, s[56:59], s73 offen sc1
    s_add_u32 s73, s73, 5120
    s_waitcnt lgkmcnt(15)
    buffer_store_dwordx4 v[24:27], v2, s[56:59], s74 offen sc1
    s_add_u32 s74, s74, 5120
    s_waitcnt lgkmcnt(15)
    buffer_store_dwordx4 v[28:31], v2, s[56:59], s75 offen sc1
    s_add_u32 s75, s75, 5120
    s_waitcnt lgkmcnt(15)
    buffer_store_dwordx4 v[32:35], v2, s[56:59], s72 offen sc1
    s_add_u32 s72, s72, 5120
    s_waitcnt lgkmcnt(15)
    buffer_store_dwordx4 v[36:39], v2, s[56:59], s73 offen sc1
    s_add_u32 s73, s73, 5120
    s_waitcnt lgkmcnt(15)
    buffer_store_dwordx4 v[40:43], v2, s[56:59], s74 offen sc1
    s_add_u32 s74, s74, 5120
    s_waitcnt lgkmcnt(15)
    buffer_store_dwordx4 v[44:47], v2, s[56:59], s75 offen sc1
    s_add_u32 s75, s75, 5120
    s_waitcnt lgkmcnt(14)
    buffer_store_dwordx4 v[48:51], v2, s[56:59], s72 offen sc1
    s_add_u32 s72, s72, 5120
    s_waitcnt lgkmcnt(12)
    buffer_store_dwordx4 v[52:55], v2, s[56:59], s73 offen sc1
    s_add_u32 s73, s73, 5120
    s_waitcnt lgkmcnt(10)
    buffer_store_dwordx4 v[56:59], v2, s[56:59], s74 offen sc1
    s_add_u32 s74, s74, 5120
    s_waitcnt lgkmcnt(8)
    buffer_store_dwordx4 v[60:63], v2, s[56:59], s75 offen sc1
    s_add_u32 s75, s75, 5120
    s_waitcnt lgkmcnt(6)
    buffer_store_dwordx4 v[64:67], v2, s[56:59], s72 offen sc1
    s_add_u32 s72, s72, 5120
    s_waitcnt lgkmcnt(4)
    buffer_store_dwordx4 v[68:71], v2, s[56:59], s73 offen sc1
    s_add_u32 s73, s73, 5120
    s_waitcnt lgkmcnt(2)
    buffer_store_dwordx4 v[72:75], v2, s[56:59], s74 offen sc1
    s_add_u32 s74, s74, 5120
    s_waitcnt lgkmcnt(0)
    buffer_store_dwordx4 v[76:79], v2, s[56:59], s75 offen sc1
    s_add_u32 s75, s75, 5120
    s_cmp_lt_u32 s76, 4
    s_cselect_b32 s10, -1, 0
    s_cmp_ge_u32 s76, 1
    s_cselect_b32 s11, -1, 0
    s_waitcnt vmcnt(0)
    s_mov_b64 exec, s[10:11]
    v_mov_b32 v4, s4
    buffer_store_dword v4, v5, s[56:59], s12 offen sc1
    s_mov_b64 exec, -1
    s_endpgm
LUPD:
    s_waitcnt lgkmcnt(0)
    s_mov_b32 s56, s46
    s_mov_b32 s57, s47
    s_mov_b32 s58, 16777216
    s_mov_b32 s59, 0x20000
    s_mov_b32 s96, s46
    s_mov_b32 s97, s47
    s_load_dword s4, s[46:47], 0
    s_waitcnt lgkmcnt(0)
    s_add_u32 s4, s4, 1
    s_barrier
    s_barrier
    v_lshrrev_b32 v2, 3, v1
    v_lshlrev_b32 v2, 10, v2
    v_and_b32 v3, 7, v1
    v_lshl_add_u32 v2, v3, 4, v2
    v_lshlrev_b32 v3, 4, v1
    v_min_u32 v4, 31, v1
    v_lshlrev_b32 v4, 4, v4
    s_mov_b32 s15, 20000
Lup0:
    s_mov_b32 s12, 283648
    buffer_load_dwordx4 v[8:11], v3, s[56:59], s12 offen sc1
    s_mov_b32 s12, 284672
    buffer_load_dwordx4 v[12:15], v3, s[56:59], s12 offen sc1
    s_mov_b32 s12, 285696
    buffer_load_dwordx4 v[16:19], v4, s[56:59], s12 offen sc1
    s_waitcnt vmcnt(0)
    v_xor_b32 v8, s4, v8
    v_xor_b32 v9, s4, v9
    v_xor_b32 v10, s4, v10
    v_xor_b32 v11, s4, v11
    v_xor_b32 v12, s4, v12
    v_xor_b32 v13, s4, v13
    v_xor_b32 v14, s4, v14
    v_xor_b32 v15, s4, v15
    v_xor_b32 v16, s4, v16
    v_xor_b32 v17, s4, v17
    v_xor_b32 v18, s4, v18
    v_xor_b32 v19, s4, v19
    v_or3_b32 v8, v8, v9, v10
    v_or3_b32 v8, v8, v11, v12
    v_or3_b32 v8, v8, v13, v14
    v_or3_b32 v8, v8, v15, v16
    v_or3_b32 v8, v8, v17, v18
    v_or_b32 v8, v8, v19
    v_cmp_ne_u32 vcc, 0, v8
    s_cbranch_vccz Lupd0
    s_sleep 8
    s_sub_u32 s15, s15, 1
    s_cbranch_scc0 Lup0
Lupd0:
    s_mov_b32 s15, 20000
Lup1:
    s_mov_b32 s12, 262144
    buffer_load_dwordx4 v[8:11], v3, s[56:59], s12 offen sc1
    s_mov_b32 s12, 263168
    buffer_load_dwordx4 v[12:15], v3, s[56:59], s12 offen sc1
    s_mov_b32 s12, 264192
    buffer_load_dwordx4 v[16:19], v4, s[56:59], s12 offen sc1
    s_mov_b32 s12, 98304
    buffer_load_dwordx4 v[20:23], v2, s[56:59], s12 offen sc1
    s_mov_b32 s12, 106496
    buffer_load_dwordx4 v[24:27], v2, s[56:59], s12 offen sc1
    s_mov_b32 s12, 114688
    buffer_load_dwordx4 v[28:31], v2, s[56:59], s12 offen sc1
    s_mov_b32 s12, 122880
    buffer_load_dwordx4 v[32:35], v2, s[56:59], s12 offen sc1
    s_waitcnt vmcnt(0)
    v_xor_b32 v8, s4, v8
    v_xor_b32 v9, s4, v9
    v_xor_b32 v10, s4, v10
    v_xor_b32 v11, s4, v11
    v_xor_b32 v12, s4, v12
    v_xor_b32 v13, s4, v13
    v_xor_b32 v14, s4, v14
    v_xor_b32 v15, s4, v15
    v_xor_b32 v16, s4, v16
    v_xor_b32 v17, s4, v17
    v_xor_b32 v18, s4, v18
    v_xor_b32 v19, s4, v19
    v_xor_b32 v20, s4, v20
    v_xor_b32 v21, s4, v21
    v_xor_b32 v22, s4, v22
    v_xor_b32 v23, s4, v23
    v_xor_b32 v24, s4, v24
    v_xor_b32 v25, s4, v25
    v_xor_b32 v26, s4, v26
    v_xor_b32 v27, s4, v27
    v_xor_b32 v28, s4, v28
    v_xor_b32 v29, s4, v29
    v_xor_b32 v30, s4, v30
    v_xor_b32 v31, s4, v31
    v_xor_b32 v32, s4, v32
    v_xor_b32 v33, s4, v33
    v_xor_b32 v34, s4, v34
    v_xor_b32 v35, s4, v35
    v_or3_b32 v8, v8, v9, v10
    v_or3_b32 v8, v8, v11, v12
    v_or3_b32 v8, v8, v13, v14
    v_or3_b32 v8, v8, v15, v16
    v_or3_b32 v8, v8, v17, v18
    v_or3_b32 v8, v8, v19, v20
    v_or3_b32 v8, v8, v21, v22
    v_or3_b32 v8, v8, v23, v24
    v_or3_b32 v8, v8, v25, v26
    v_or3_b32 v8, v8, v27, v28
    v_or3_b32 v8, v8, v29, v30
    v_or3_b32 v8, v8, v31, v32
    v_or3_b32 v8, v8, v33, v34
    v_or_b32 v8, v8, v35
    v_cmp_ne_u32 vcc, 0, v8
    s_cbranch_vccz Lupd1
    s_sleep 8
    s_sub_u32 s15, s15, 1
    s_cbranch_scc0 Lup1
Lupd1:
    s_mov_b32 s12, 0
    v_mov_b32 v4, s4
    v_mul_u32_u24 v5, 128, v1
    s_mov_b32 exec_lo, 0x1
    s_mov_b32 exec_hi, 0
    buffer_store_dword v4, v5, s[56:59], s12 offen sc1
    s_mov_b64 exec, -1
    s_endpgm
Lexit:
    s_endpgm
.section .rodata,"a"
.p2align 6
.amdhsa_kernel gated_mix__ssm_conv_s4__dense_activation_relu__prompt_kernel
  .amdhsa_next_free_vgpr 256
  .amdhsa_next_free_sgpr 102
  .amdhsa_accum_offset 256
  .amdhsa_group_segment_fixed_size 0
  .amdhsa_kernarg_size 128
  .amdhsa_user_sgpr_count 2
  .amdhsa_user_sgpr_kernarg_segment_ptr 1
  .amdhsa_system_sgpr_workgroup_id_x 1
  .amdhsa_float_denorm_mode_32 3
.end_amdhsa_kernel
```
